```python
import torch

def _softmax(x, axis=-1):
    return torch.softmax(x, dim=axis)
def _gelu(x):
    return torch.nn.functional.gelu(x, approximate="tanh")
def _silu(x):
    return torch.nn.functional.silu(x)
def _sigmoid(x):
    return torch.sigmoid(x)
def _layernorm(x, axis=-1, eps=1e-5):
    m = x.mean(dim=axis, keepdim=True)
    v = x.var(dim=axis, keepdim=True, unbiased=False)
    return (x - m) / torch.sqrt(v + eps)
def _scatter_add(tgt, idx, src, axis=0):
    return tgt.clone().index_add_(axis, idx, src)
def _segment_sum(src, seg, n):
    out = torch.zeros((n,) + src.shape[1:], dtype=src.dtype)
    return out.index_add_(0, seg, src)
def _pad(x, pw):
    flat = tuple(v for pair in reversed(pw) for v in pair)
    return torch.nn.functional.pad(x, flat)

kernel_name = 'parallel_sum__sliding_block_cached__dense_activation_squared_relu__decode'

def setup_inputs():

    _w = (lambda a: (lambda t: t.to(torch.bfloat16) if t.is_floating_point() else t)(torch.as_tensor(a)))
    def _A_setup():
        B, Sq, D = 1, 1, 576
        Hq, Hkv, Sk, Dh = 32, 16, 65536, 128
        assert Hq % Hkv == 0, (Hq, Hkv)
        return {
            "x": _w((lambda *s: torch.randn(*s, dtype=torch.bfloat16) * 0.05)(B, Sq, D)),
            "k_cache": _w((lambda *s: torch.randn(*s, dtype=torch.bfloat16) * 3.2)(B, Hkv, Sk, Dh)),
            "v_cache": _w((lambda *s: torch.randn(*s, dtype=torch.bfloat16) * 3.2)(B, Hkv, Sk, Dh)),
            "wq": _w((lambda *s: torch.randn(*s, dtype=torch.bfloat16) * 3.2)(D, Hq * Dh) * (D ** -0.5)),
            "wo": _w((lambda *s: torch.randn(*s, dtype=torch.bfloat16) * 3.2)(Hq * Dh, D) * ((Hq * Dh) ** -0.5)),
        }
    _A_in = _A_setup()

    def _B_setup():
        B, S, D, F = 1, 1, 576, 4608
        return {
            "x": _w((lambda *s: torch.randn(*s, dtype=torch.bfloat16) * 0.05)(B, S, D)),
            "w1": _w((lambda *s: torch.randn(*s, dtype=torch.bfloat16) * 0.05)(D, F)),
            "b1": _w((lambda *s: torch.randn(*s, dtype=torch.bfloat16) * 0.8)(F)),
            "w2": _w((lambda *s: torch.randn(*s, dtype=torch.bfloat16) * 0.05)(F, D)),
            "b2": _w((lambda *s: torch.randn(*s, dtype=torch.bfloat16) * 3.2)(D)),
        }
    _B_in = _B_setup()

    return {
        "A_x": _A_in["x"],
        "A_k_cache": _A_in["k_cache"],
        "A_v_cache": _A_in["v_cache"],
        "A_wq": _A_in["wq"],
        "A_wo": _A_in["wo"],
        "B_x": _B_in["x"],
        "B_w1": _B_in["w1"],
        "B_b1": _B_in["b1"],
        "B_w2": _B_in["w2"],
        "B_b2": _B_in["b2"],
    }

def reference(A_x, A_k_cache, A_v_cache, A_wq, A_wo, B_x, B_w1, B_b1, B_w2, B_b2):
    def _A_ref(x, k_cache, v_cache, wq, wo):
        B, Sq, D = x.shape
        Hq, Dh = 32, 128
        Hkv, Sk = k_cache.shape[1], k_cache.shape[2]
        W = min(4096, max(256, Sk // 4))
        rep = Hq // Hkv
        q = (lambda x, *d: x.permute(*d))((x @ wq).reshape(B, Sq, Hq, Dh), 0, 2, 1, 3)
        k = (lambda x, n, axis: torch.repeat_interleave(x, n, dim=axis))(k_cache[:, :, Sk - W:, :], rep, axis=1)
        v = (lambda x, n, axis: torch.repeat_interleave(x, n, dim=axis))(v_cache[:, :, Sk - W:, :], rep, axis=1)
        scores = torch.einsum("bhqd,bhkd->bhqk", q, k) * (Dh ** -0.5)
        p = _softmax(scores, axis=-1)
        o = torch.einsum("bhqk,bhkd->bhqd", p, v)
        return (lambda x, *d: x.permute(*d))(o, 0, 2, 1, 3).reshape(B, Sq, Hq * Dh) @ wo

    def _B_ref(x, w1, b1, w2, b2):
        h = torch.einsum("bsd,df->bsf", x, w1) + b1
        zero = torch.zeros_like(h)
        r = torch.where(h > zero, h, zero)
        h = r * r
        out = torch.einsum("bsf,fd->bsd", h, w2) + b2
        return out

    x = A_x
    xn = _layernorm(x, axis=-1)
    return x + _A_ref(xn, A_k_cache, A_v_cache, A_wq, A_wo) + _B_ref(xn, B_w1, B_b1, B_w2, B_b2)
```

```asm
; @launch grid=(256,1,1) block=(384,1,1) lds=163840
.amdgcn_target "amdgcn-amd-amdhsa--gfx950"
.text
.p2align 12
.globl parallel_sum__sliding_block_cached__dense_activation_squared_relu__decode_kernel
.p2align 8
.type parallel_sum__sliding_block_cached__dense_activation_squared_relu__decode_kernel,@function
parallel_sum__sliding_block_cached__dense_activation_squared_relu__decode_kernel:
  s_cmp_ge_u32 s2, 256
  s_cbranch_scc1 L_end
  s_load_dwordx2 s[12:13], s[0:1], 24
  s_load_dwordx2 s[8:9], s[0:1], 0
  s_load_dwordx2 s[16:17], s[0:1], 48
  s_load_dwordx2 s[20:21], s[0:1], 8
  s_load_dwordx2 s[24:25], s[0:1], 16
  s_load_dwordx2 s[36:37], s[0:1], 96
  v_lshrrev_b32 v1, 6, v0
  v_and_b32 v0, 63, v0
  v_readfirstlane_b32 s3, v1
  s_and_b32 s4, s2, 7
  s_lshr_b32 s5, s2, 3
  s_lshr_b32 s52, s5, 4
  s_lshl_b32 s6, s4, 1
  s_add_u32 s52, s52, s6
  s_and_b32 s53, s5, 15
  s_lshr_b32 s54, s5, 3
  s_lshl_b32 s6, s4, 2
  s_add_u32 s54, s54, s6
  s_and_b32 s55, s5, 7
  v_lshrrev_b32 v1, 4, v0
  v_and_b32 v2, 15, v0
  v_mov_b32 v7, 0
  s_cmp_lt_u32 s3, 5
  s_cbranch_scc1 L_other
  s_setprio 3
  s_mov_b32 s14, 4718592
  s_mov_b32 s15, 0x20000
  v_lshrrev_b32 v9, 3, v0
  v_lshlrev_b32 v10, 13, v9
  v_and_b32 v9, 7, v0
  v_lshl_add_u32 v10, v9, 4, v10
  s_lshr_b32 s4, s53, 2
  s_mul_i32 s56, s4, 1179648
  s_lshl_b32 s6, s52, 9
  s_add_u32 s56, s56, s6
  s_and_b32 s6, s53, 3
  s_lshl_b32 s6, s6, 7
  s_add_u32 s56, s56, s6
  s_mov_b32 m0, 14080
  s_movk_i32 s64, 1024
  s_mov_b32 s65, 65536
  s_movk_i32 s50, 17
  s_waitcnt lgkmcnt(0)
L_lq:
  buffer_load_dwordx4 v10, s[12:15], s56 offen nt lds
  s_add_u32 m0, m0, s64
  s_add_u32 s56, s56, s65
  s_sub_u32 s50, s50, 1
  s_cbranch_scc0 L_lq
  s_mov_b32 s18, 5308416
  s_mov_b32 s19, 0x20000
  v_mul_u32_u24 v9, 57, v0
  v_lshrrev_b32 v9, 9, v9
  v_mul_u32_u24 v15, 9, v9
  v_sub_u32 v15, v0, v15
  v_mul_u32_u24 v11, 9216, v9
  v_lshl_add_u32 v11, v15, 4, v11
  v_mul_u32_u24 v12, 1152, v9
  v_lshl_add_u32 v12, v15, 4, v12
  s_lshr_b32 s5, s55, 1
  s_mul_i32 s57, s5, 1327104
  s_mul_i32 s6, s54, 288
  s_add_u32 s57, s57, s6
  s_and_b32 s6, s55, 1
  s_mul_i32 s6, s6, 144
  s_add_u32 s57, s57, s6
  s_mov_b32 m0, 142336
  s_movk_i32 s64, 1008
  s_mov_b32 s65, 64512
  s_movk_i32 s50, 5
  s_mov_b32 exec_hi, 0x7fffffff
L_l1a:
  buffer_load_dwordx4 v11, s[16:19], s57 offen nt lds
  s_add_u32 m0, m0, s64
  s_add_u32 s57, s57, s65
  s_sub_u32 s50, s50, 1
  s_cbranch_scc0 L_l1a
  s_mov_b32 exec_hi, -1
  s_barrier
  s_branch L_load2
L_other:
  s_cmp_eq_u32 s3, 4
  s_cbranch_scc1 L_sync
  s_mov_b32 s10, 1152
  s_mov_b32 s11, 0x20000
  v_lshlrev_b32 v21, 4, v0
  v_lshlrev_b32 v22, 2, v0
  v_add_u32 v22, 1024, v22
  s_waitcnt lgkmcnt(0)
  buffer_load_dwordx4 v[24:27], v21, s[8:11], 0 offen
  buffer_load_dword v28, v22, s[8:11], 0 offen
  s_barrier
  s_branch L_comp
L_sync:
  s_setprio 2
  s_getpc_b64 s[6:7]
L_pcref:
  s_sub_u32 s6, s6, (L_pcref - parallel_sum__sliding_block_cached__dense_activation_squared_relu__decode_kernel)
  s_subb_u32 s7, s7, 0
  s_lshr_b32 s5, s2, 3
  s_and_b32 s5, s5, 15
  s_lshl_b32 s5, s5, 10
  s_min_u32 s5, s5, (L_end + 4 - parallel_sum__sliding_block_cached__dense_activation_squared_relu__decode_kernel - 1024)
  v_lshlrev_b32 v10, 4, v0
  v_add_u32 v10, s5, v10
  global_load_dwordx4 v[120:123], v10, s[6:7]
  s_mov_b32 s38, 2097152
  s_mov_b32 s39, 0x20000
  v_mov_b32 v20, 0
  v_mov_b32 v21, 0
  v_mov_b32 v22, 0
  v_mov_b32 v23, 0
  s_mov_b64 exec, 1
  ds_write_b128 v7, v[20:23] offset:0
  ds_write_b128 v7, v[20:23] offset:16
  ds_write_b128 v7, v[20:23] offset:32
  ds_write_b32 v7, v20 offset:11424
  s_mov_b64 exec, -1
  s_waitcnt lgkmcnt(0)
  buffer_load_dword v4, v7, s[36:39], 0 offen sc1
  s_barrier
  s_branch L_sync_t
L_comp:
  s_load_dwordx2 s[44:45], s[0:1], 72
  s_load_dwordx2 s[48:49], s[0:1], 80
  s_mov_b32 s38, 2097152
  s_mov_b32 s39, 0x20000
  v_and_b32 v22, 1, v0
  v_mov_b32 v23, 0xffff
  v_lshlrev_b32 v22, 4, v22
  v_lshlrev_b32 v22, v22, v23
  v_bfe_u32 v23, v0, 1, 2
  v_cmp_eq_u32 vcc, 0, v23
  s_nop 1
  v_cndmask_b32 v3, 0, v22, vcc
  v_cmp_eq_u32 vcc, 1, v23
  s_nop 1
  v_cndmask_b32 v4, 0, v22, vcc
  v_cmp_eq_u32 vcc, 2, v23
  s_nop 1
  v_cndmask_b32 v5, 0, v22, vcc
  v_cmp_eq_u32 vcc, 3, v23
  s_nop 1
  v_cndmask_b32 v6, 0, v22, vcc
  s_lshl_b32 s4, s3, 10
  s_add_u32 s4, s4, 14080
  v_add_u32 v9, s4, v21
  s_lshr_b32 s4, s53, 2
  s_mul_i32 s4, s4, 144
  s_lshl_b32 s5, s3, 3
  s_add_u32 s4, s4, s5
  v_lshrrev_b32 v22, 3, v0
  v_add_u32 v22, s4, v22
  v_lshlrev_b32 v10, 2, v22
  s_mul_i32 s5, s3, 36
  v_add_u32 v22, s5, v1
  v_mul_u32_u24 v23, 144, v22
  v_lshl_add_u32 v23, v2, 4, v23
  v_add_u32 v11, 142336, v23
  s_lshr_b32 s4, s55, 1
  s_mul_i32 s4, s4, 144
  v_add_u32 v22, s4, v22
  v_lshlrev_b32 v12, 2, v22
  v_mov_b32 v21, 1
  s_mov_b32 s65, 0
  s_waitcnt vmcnt(0)
  v_lshlrev_b32 v30, 16, v24
  v_and_b32 v31, 0xffff0000, v24
  v_lshlrev_b32 v32, 16, v25
  v_and_b32 v33, 0xffff0000, v25
  v_lshlrev_b32 v34, 16, v26
  v_and_b32 v35, 0xffff0000, v26
  v_lshlrev_b32 v36, 16, v27
  v_and_b32 v37, 0xffff0000, v27
  v_lshlrev_b32 v38, 16, v28
  v_and_b32 v39, 0xffff0000, v28
  v_add_f32 v40, v30, v31
  v_add_f32 v41, v32, v33
  v_add_f32 v42, v34, v35
  v_add_f32 v43, v36, v37
  v_add_f32 v40, v40, v41
  v_add_f32 v42, v42, v43
  v_add_f32 v41, v38, v39
  v_add_f32 v40, v40, v42
  v_add_f32 v40, v40, v41
  s_nop 1
  v_add_f32_dpp v40, v40, v40 quad_perm:[1,0,3,2] row_mask:0xf bank_mask:0xf
  s_nop 1
  v_add_f32_dpp v40, v40, v40 quad_perm:[2,3,0,1] row_mask:0xf bank_mask:0xf
  s_nop 1
  v_add_f32_dpp v40, v40, v40 row_half_mirror row_mask:0xf bank_mask:0xf
  s_nop 1
  v_add_f32_dpp v40, v40, v40 row_mirror row_mask:0xf bank_mask:0xf
  v_mov_b32 v41, v40
  s_nop 1
  v_permlane16_swap_b32 v40, v41
  s_nop 0
  v_add_f32 v40, v40, v41
  v_mov_b32 v41, v40
  s_nop 1
  v_permlane32_swap_b32 v40, v41
  s_nop 0
  v_add_f32 v40, v40, v41
  v_mul_f32 v61, 0x3ae38e39, v40
  v_mov_b32 v41, 0x44100000
  v_fma_f32 v41, -v61, v41, v40
  v_fmac_f32 v61, 0x3ae38e39, v41
  v_cmp_gt_u32 vcc, 32, v0
  v_sub_f32 v62, v30, v61
  v_mul_f32 v40, v62, v62
  v_sub_f32 v62, v31, v61
  v_fmac_f32 v40, v62, v62
  v_sub_f32 v62, v32, v61
  v_fmac_f32 v40, v62, v62
  v_sub_f32 v62, v33, v61
  v_fmac_f32 v40, v62, v62
  v_sub_f32 v62, v34, v61
  v_fmac_f32 v40, v62, v62
  v_sub_f32 v62, v35, v61
  v_fmac_f32 v40, v62, v62
  v_sub_f32 v62, v36, v61
  v_fmac_f32 v40, v62, v62
  v_sub_f32 v62, v37, v61
  v_fmac_f32 v40, v62, v62
  v_sub_f32 v62, v38, v61
  v_cndmask_b32 v62, 0, v62, vcc
  v_fmac_f32 v40, v62, v62
  v_sub_f32 v62, v39, v61
  v_cndmask_b32 v62, 0, v62, vcc
  v_fmac_f32 v40, v62, v62
  s_nop 1
  v_add_f32_dpp v40, v40, v40 quad_perm:[1,0,3,2] row_mask:0xf bank_mask:0xf
  s_nop 1
  v_add_f32_dpp v40, v40, v40 quad_perm:[2,3,0,1] row_mask:0xf bank_mask:0xf
  s_nop 1
  v_add_f32_dpp v40, v40, v40 row_half_mirror row_mask:0xf bank_mask:0xf
  s_nop 1
  v_add_f32_dpp v40, v40, v40 row_mirror row_mask:0xf bank_mask:0xf
  v_mov_b32 v41, v40
  s_nop 1
  v_permlane16_swap_b32 v40, v41
  s_nop 0
  v_add_f32 v40, v40, v41
  v_mov_b32 v41, v40
  s_nop 1
  v_permlane32_swap_b32 v40, v41
  s_nop 0
  v_add_f32 v40, v40, v41
  v_mul_f32 v42, 0x3ae38e39, v40
  v_mov_b32 v41, 0x44100000
  v_fma_f32 v41, -v42, v41, v40
  v_fmac_f32 v42, 0x3ae38e39, v41
  v_cvt_pk_bf16_f32 v42, v42, v42
  v_and_b32 v42, 0xffff0000, v42
  v_add_f32 v42, 0x3727c5ac, v42
  v_cvt_pk_bf16_f32 v42, v42, v42
  v_and_b32 v42, 0xffff0000, v42
  v_sqrt_f32 v42, v42
  s_nop 0
  v_cvt_pk_bf16_f32 v42, v42, v42
  v_and_b32 v42, 0xffff0000, v42
  v_rcp_f32 v43, v42
  v_cvt_pk_bf16_f32 v61, v61, v61
  v_and_b32 v61, 0xffff0000, v61
  v_sub_f32 v30, v30, v61
  v_sub_f32 v31, v31, v61
  v_sub_f32 v32, v32, v61
  v_sub_f32 v33, v33, v61
  v_sub_f32 v34, v34, v61
  v_sub_f32 v35, v35, v61
  v_sub_f32 v36, v36, v61
  v_sub_f32 v37, v37, v61
  v_sub_f32 v38, v38, v61
  v_sub_f32 v39, v39, v61
  v_cvt_pk_bf16_f32 v62, v30, v31
  v_lshlrev_b32 v30, 16, v62
  v_and_b32 v31, 0xffff0000, v62
  v_cvt_pk_bf16_f32 v62, v32, v33
  v_lshlrev_b32 v32, 16, v62
  v_and_b32 v33, 0xffff0000, v62
  v_cvt_pk_bf16_f32 v62, v34, v35
  v_lshlrev_b32 v34, 16, v62
  v_and_b32 v35, 0xffff0000, v62
  v_cvt_pk_bf16_f32 v62, v36, v37
  v_lshlrev_b32 v36, 16, v62
  v_and_b32 v37, 0xffff0000, v62
  v_cvt_pk_bf16_f32 v62, v38, v39
  v_lshlrev_b32 v38, 16, v62
  v_and_b32 v39, 0xffff0000, v62
  v_mul_f32 v62, v30, v43
  v_fma_f32 v40, -v62, v42, v30
  v_fma_f32 v62, v40, v43, v62
  v_cvt_pk_bf16_f32 v64, v62, v62
  v_mul_f32 v62, v31, v43
  v_fma_f32 v40, -v62, v42, v31
  v_fma_f32 v62, v40, v43, v62
  v_cvt_pk_bf16_f32 v65, v62, v62
  v_mul_f32 v62, v32, v43
  v_fma_f32 v40, -v62, v42, v32
  v_fma_f32 v62, v40, v43, v62
  v_cvt_pk_bf16_f32 v66, v62, v62
  v_mul_f32 v62, v33, v43
  v_fma_f32 v40, -v62, v42, v33
  v_fma_f32 v62, v40, v43, v62
  v_cvt_pk_bf16_f32 v67, v62, v62
  v_mul_f32 v62, v34, v43
  v_fma_f32 v40, -v62, v42, v34
  v_fma_f32 v62, v40, v43, v62
  v_cvt_pk_bf16_f32 v68, v62, v62
  v_mul_f32 v62, v35, v43
  v_fma_f32 v40, -v62, v42, v35
  v_fma_f32 v62, v40, v43, v62
  v_cvt_pk_bf16_f32 v69, v62, v62
  v_mul_f32 v62, v36, v43
  v_fma_f32 v40, -v62, v42, v36
  v_fma_f32 v62, v40, v43, v62
  v_cvt_pk_bf16_f32 v70, v62, v62
  v_mul_f32 v62, v37, v43
  v_fma_f32 v40, -v62, v42, v37
  v_fma_f32 v62, v40, v43, v62
  v_cvt_pk_bf16_f32 v71, v62, v62
  v_mul_f32 v62, v38, v43
  v_fma_f32 v40, -v62, v42, v38
  v_fma_f32 v62, v40, v43, v62
  v_cvt_pk_bf16_f32 v72, v62, v62
  v_mul_f32 v62, v39, v43
  v_fma_f32 v40, -v62, v42, v39
  v_fma_f32 v62, v40, v43, v62
  v_cvt_pk_bf16_f32 v73, v62, v62
  v_lshlrev_b32 v22, 5, v0
  ds_write_b128 v22, v[64:67] offset:64
  ds_write_b128 v22, v[68:71] offset:80
  v_lshlrev_b32 v22, 3, v0
  ds_write_b64 v22, v[72:73] offset:2112
  s_waitcnt lgkmcnt(0)
  ds_read_b32 v56, v10 offset:64
  ds_read_b32 v57, v10 offset:192
  ds_read_b32 v58, v10 offset:320
  ds_read_b32 v59, v10 offset:448
  ds_read_b32 v60, v10 offset:576
  ds_read_b32 v44, v12 offset:64
  ds_read_b32 v45, v12 offset:80
  ds_read_b32 v46, v12 offset:96
  ds_read_b32 v47, v12 offset:112
  ds_read_b32 v48, v12 offset:128
  ds_read_b32 v49, v12 offset:144
  ds_read_b32 v50, v12 offset:160
  ds_read_b32 v51, v12 offset:176
  ds_read_b32 v52, v12 offset:192
  s_branch L_comp_t
L_load2:
  s_load_dwordx2 s[28:29], s[0:1], 32
  s_load_dwordx2 s[32:33], s[0:1], 64
  s_mov_b32 s22, 268435456
  s_mov_b32 s23, 0x20000
  s_mov_b32 s26, 268435456
  s_mov_b32 s27, 0x20000
  s_lshl_b32 s58, s52, 24
  s_add_u32 s58, s58, 0xF00000
  s_lshl_b32 s6, s53, 16
  s_add_u32 s58, s58, s6
  s_mul_i32 s6, s52, 5
  s_mul_i32 s7, s53, 1
  s_add_u32 s6, s6, s7
  s_and_b32 s6, s6, 15
  s_lshl_b32 s6, s6, 12
  s_or_b32 s58, s58, s6
  v_add_u32 v9, 0, v1
  v_xor_b32 v9, v9, v2
  v_lshlrev_b32 v9, 4, v9
  v_lshl_add_u32 v16, v1, 8, v9
  v_add_u32 v9, 4, v1
  v_xor_b32 v9, v9, v2
  v_lshlrev_b32 v9, 4, v9
  v_lshl_add_u32 v17, v1, 8, v9
  v_add_u32 v9, 8, v1
  v_xor_b32 v9, v9, v2
  v_lshlrev_b32 v9, 4, v9
  v_lshl_add_u32 v18, v1, 8, v9
  v_add_u32 v9, 12, v1
  v_xor_b32 v9, v9, v2
  v_lshlrev_b32 v9, 4, v9
  v_lshl_add_u32 v19, v1, 8, v9
  v_or_b32 v9, 0, v1
  v_lshlrev_b32 v9, 1, v9
  v_xor_b32 v9, v9, v2
  v_lshlrev_b32 v9, 4, v9
  v_lshl_add_u32 v13, v1, 8, v9
  v_or_b32 v9, 4, v1
  v_lshlrev_b32 v9, 1, v9
  v_xor_b32 v9, v9, v2
  v_lshlrev_b32 v9, 4, v9
  v_lshl_add_u32 v15, v1, 8, v9
  v_lshlrev_b32 v20, 2, v0
  v_mov_b32 v14, 0
  s_mov_b32 exec_hi, 0x7fffffff
  s_movk_i32 s50, 13
L_l1b:
  s_waitcnt vmcnt(23)
  v_add_u32 v14, 1, v14
  ds_write_b32 v20, v14 offset:11424
  buffer_load_dwordx4 v11, s[16:19], s57 offen nt lds
  s_add_u32 m0, m0, s64
  s_add_u32 s57, s57, s65
  s_sub_u32 s50, s50, 1
  s_cbranch_scc0 L_l1b
  s_mov_b32 exec_hi, 0xf
  s_waitcnt vmcnt(23)
  v_add_u32 v14, 1, v14
  ds_write_b32 v20, v14 offset:11424
  buffer_load_dwordx4 v11, s[16:19], s57 offen nt lds
  s_mov_b32 exec_hi, -1
  s_mov_b32 s50, 0
L_lk:
  s_and_b32 s4, s50, 3
  s_lshl_b32 s4, s4, 14
  s_lshr_b32 s5, s50, 2
  s_lshl_b32 s5, s5, 12
  s_or_b32 s4, s4, s5
  s_xor_b32 s61, s58, s4
  s_waitcnt vmcnt(20)
  s_add_u32 m0, s4, 32768
  v_add_u32 v14, 4, v14
  ds_write_b32 v20, v14 offset:11424
  buffer_load_dwordx4 v16, s[20:23], s61 offen offset:0 nt lds
  buffer_load_dwordx4 v17, s[20:23], s61 offen offset:1024 nt lds
  buffer_load_dwordx4 v18, s[20:23], s61 offen offset:2048 nt lds
  buffer_load_dwordx4 v19, s[20:23], s61 offen offset:3072 nt lds
  s_add_u32 s50, s50, 1
  s_cmp_lt_u32 s50, 16
  s_cbranch_scc1 L_lk
  s_waitcnt lgkmcnt(0)
  s_mov_b32 s30, 4718592
  s_mov_b32 s31, 0x20000
  s_mov_b32 s34, 5308416
  s_mov_b32 s35, 0x20000
  s_mul_i32 s59, s54, 147456
  s_mul_i32 s6, s55, 144
  s_add_u32 s59, s59, s6
  s_mul_i32 s60, s54, 165888
  s_add_u32 s60, s60, s6
  s_mov_b32 s63, 2000000
L_sp1:
  ds_read_b32 v8, v7 offset:8
  s_sub_u32 s63, s63, 1
  s_cbranch_scc1 L_spx2
  s_waitcnt lgkmcnt(0)
  v_readfirstlane_b32 s62, v8
  s_cmp_ge_u32 s62, 4
  s_cbranch_scc0 L_sp1
L_spx2:
  s_mov_b32 s4, 0
L_lv:
  s_xor_b32 s61, s58, s4
  s_waitcnt vmcnt(20)
  s_add_u32 m0, s4, 98304
  v_add_u32 v14, 4, v14
  ds_write_b32 v20, v14 offset:11424
  buffer_load_dwordx4 v13, s[24:27], s61 offen offset:0 nt lds
  buffer_load_dwordx4 v13, s[24:27], s61 offen offset:1024 nt lds
  buffer_load_dwordx4 v15, s[24:27], s61 offen offset:2048 nt lds
  buffer_load_dwordx4 v15, s[24:27], s61 offen offset:3072 nt lds
  s_add_u32 s4, s4, 4096
  s_cmp_lt_u32 s4, 65536
  s_cbranch_scc1 L_lv
  s_mov_b32 m0, 14080
  s_movk_i32 s65, 8064
  s_mov_b32 exec_hi, 0x7fffffff
  s_movk_i32 s50, 17
L_lo:
  s_waitcnt vmcnt(23)
  v_add_u32 v14, 1, v14
  ds_write_b32 v20, v14 offset:11424
  buffer_load_dwordx4 v12, s[28:31], s59 offen nt lds
  s_add_u32 m0, m0, s64
  s_add_u32 s59, s59, s65
  s_sub_u32 s50, s50, 1
  s_cbranch_scc0 L_lo
  s_mov_b32 exec_hi, 0
  s_mov_b32 exec_lo, 0x3ffff
  s_waitcnt vmcnt(23)
  v_add_u32 v14, 1, v14
  ds_write_b32 v20, v14 offset:11424
  buffer_load_dwordx4 v12, s[28:31], s59 offen nt lds
  s_mov_b64 exec, -1
  s_mov_b32 s63, 2000000
L_sp3:
  ds_read_b32 v8, v7 offset:12
  s_sub_u32 s63, s63, 1
  s_cbranch_scc1 L_spx4
  s_waitcnt lgkmcnt(0)
  v_readfirstlane_b32 s62, v8
  s_cmp_ge_u32 s62, 4
  s_cbranch_scc0 L_sp3
L_spx4:
  s_mov_b32 m0, 32768
  v_mov_b32 v9, 1
  s_mov_b32 s63, 2000000
L_sp5:
  ds_read_b32 v8, v7 offset:40
  s_sub_u32 s63, s63, 1
  s_cbranch_scc1 L_spx6
  s_waitcnt lgkmcnt(0)
  v_readfirstlane_b32 s62, v8
  s_cmp_ge_u32 s62, 1
  s_cbranch_scc0 L_sp5
L_spx6:
  ds_read_b32 v21, v20 offset:11680
  v_mov_b32 v24, 2146435072
  s_waitcnt lgkmcnt(0)
  s_mov_b32 exec_hi, 0x7fffffff
  s_movk_i32 s50, 9
L_lw0:
  v_and_b32 v22, 1, v21
  v_cmp_ne_u32 vcc, 0, v22
  v_lshrrev_b32 v21, 1, v21
  s_waitcnt vmcnt(23)
  v_cndmask_b32 v23, v24, v12, vcc
  v_add_u32 v14, 1, v14
  ds_write_b32 v20, v14 offset:11424
  buffer_load_dwordx4 v23, s[32:35], s60 offen nt lds
  s_add_u32 m0, m0, s64
  s_add_u32 s60, s60, s65
  s_sub_u32 s50, s50, 1
  s_cbranch_scc0 L_lw0
  s_movk_i32 s50, 9
L_lw:
  v_and_b32 v22, 1, v21
  v_cmp_ne_u32 vcc, 0, v22
  v_lshrrev_b32 v21, 1, v21
  s_nop 0
  v_cndmask_b32 v23, v24, v12, vcc
  buffer_load_dwordx4 v23, s[32:35], s60 offen nt lds
  s_add_u32 m0, m0, s64
  s_add_u32 s60, s60, s65
  s_sub_u32 s50, s50, 1
  s_cbranch_scc0 L_lw
  s_mov_b32 exec_hi, 0xf
  v_and_b32 v22, 1, v21
  v_cmp_ne_u32 vcc, 0, v22
  v_lshrrev_b32 v21, 1, v21
  s_nop 0
  v_cndmask_b32 v23, v24, v12, vcc
  buffer_load_dwordx4 v23, s[32:35], s60 offen nt lds
  s_mov_b64 exec, -1
  s_mov_b64 exec, 1
  ds_write_b32 v7, v9 offset:36
  s_mov_b64 exec, -1
  s_waitcnt vmcnt(21)
  v_add_u32 v14, 14, v14
  ds_write_b32 v20, v14 offset:11424
  s_waitcnt vmcnt(7)
  v_add_u32 v14, 14, v14
  ds_write_b32 v20, v14 offset:11424
  s_waitcnt vmcnt(2)
  v_add_u32 v14, 5, v14
  ds_write_b32 v20, v14 offset:11424
  s_waitcnt vmcnt(0)
  v_add_u32 v14, 2, v14
  ds_write_b32 v20, v14 offset:11424
  s_branch L_fin_stamps
L_comp_t:
  s_waitcnt lgkmcnt(0)
  s_cmp_ge_u32 s65, 18
  s_cbranch_scc1 L_ppx8
  s_mov_b32 s63, 2000000
L_pp7:
  ds_read_b32 v8, v7 offset:11424
  s_sub_u32 s63, s63, 1
  s_cbranch_scc1 L_ppx8
  s_waitcnt lgkmcnt(0)
  v_readfirstlane_b32 s65, v8
  s_cmp_ge_u32 s65, 18
  s_cbranch_scc0 L_pp7
L_ppx8:
  ds_read_b128 v[64:67], v9 offset:0
  ds_read_b128 v[68:71], v9 offset:4096
  ds_read_b128 v[72:75], v9 offset:8192
  ds_read_b128 v[76:79], v9 offset:12288
  s_cmp_ge_u32 s3, 2
  s_cbranch_scc1 L_q4
  ds_read_b128 v[80:83], v9 offset:16384
  s_waitcnt lgkmcnt(0)
  v_and_b32 v220, v60, v3
  v_and_b32 v221, v60, v4
  v_and_b32 v222, v60, v5
  v_and_b32 v223, v60, v6
  s_nop 1
  v_mfma_f32_16x16x32_bf16 v[208:211], v[220:223], v[80:83], 0
  s_branch L_q5
L_q4:
  v_mov_b32 v208, 0
  v_mov_b32 v209, 0
  v_mov_b32 v210, 0
  v_mov_b32 v211, 0
  s_waitcnt lgkmcnt(0)
L_q5:
  v_and_b32 v216, v56, v3
  v_and_b32 v217, v56, v4
  v_and_b32 v218, v56, v5
  v_and_b32 v219, v56, v6
  s_nop 1
  v_mfma_f32_16x16x32_bf16 v[208:211], v[216:219], v[64:67], v[208:211]
  v_and_b32 v220, v57, v3
  v_and_b32 v221, v57, v4
  v_and_b32 v222, v57, v5
  v_and_b32 v223, v57, v6
  s_nop 1
  v_mfma_f32_16x16x32_bf16 v[208:211], v[220:223], v[68:71], v[208:211]
  v_and_b32 v216, v58, v3
  v_and_b32 v217, v58, v4
  v_and_b32 v218, v58, v5
  v_and_b32 v219, v58, v6
  s_nop 1
  v_mfma_f32_16x16x32_bf16 v[208:211], v[216:219], v[72:75], v[208:211]
  v_and_b32 v220, v59, v3
  v_and_b32 v221, v59, v4
  v_and_b32 v222, v59, v5
  v_and_b32 v223, v59, v6
  s_nop 1
  v_mfma_f32_16x16x32_bf16 v[208:211], v[220:223], v[76:79], v[208:211]
  v_lshrrev_b32 v22, 3, v2
  v_lshrrev_b32 v23, 1, v1
  v_cmp_eq_u32 vcc, v22, v23
  v_lshlrev_b32 v22, 8, v22
  v_and_b32 v23, 7, v2
  v_lshl_add_u32 v22, v23, 5, v22
  v_and_b32 v23, 1, v1
  v_lshl_add_u32 v22, v23, 4, v22
  s_lshl_b32 s6, s3, 9
  v_add_u32 v22, s6, v22
  s_and_saveexec_b64 s[94:95], vcc
  s_nop 3
  ds_write_b128 v22, v[208:211] offset:2624
  s_mov_b64 exec, 1
  ds_add_u32 v7, v21 offset:4
  s_mov_b64 exec, -1
  s_cmp_ge_u32 s65, 39
  s_cbranch_scc1 L_ppx10
  s_mov_b32 s63, 2000000
L_pp9:
  ds_read_b32 v8, v7 offset:11424
  s_sub_u32 s63, s63, 1
  s_cbranch_scc1 L_ppx10
  s_waitcnt lgkmcnt(0)
  v_readfirstlane_b32 s65, v8
  s_cmp_ge_u32 s65, 39
  s_cbranch_scc0 L_pp9
L_ppx10:
  ds_read_b128 v[64:67], v11 offset:0
  ds_read_b128 v[68:71], v11 offset:576
  ds_read_b128 v[72:75], v11 offset:1152
  ds_read_b128 v[76:79], v11 offset:1728
  ds_read_b128 v[80:83], v11 offset:2304
  ds_read_b128 v[84:87], v11 offset:2880
  ds_read_b128 v[88:91], v11 offset:3456
  ds_read_b128 v[92:95], v11 offset:4032
  ds_read_b128 v[96:99], v11 offset:4608
  s_waitcnt lgkmcnt(8)
  v_and_b32 v216, v44, v3
  v_and_b32 v217, v44, v4
  v_and_b32 v218, v44, v5
  v_and_b32 v219, v44, v6
  s_nop 1
  v_mfma_f32_16x16x32_bf16 v[208:211], v[216:219], v[64:67], 0
  s_waitcnt lgkmcnt(7)
  v_and_b32 v220, v45, v3
  v_and_b32 v221, v45, v4
  v_and_b32 v222, v45, v5
  v_and_b32 v223, v45, v6
  s_nop 1
  v_mfma_f32_16x16x32_bf16 v[208:211], v[220:223], v[68:71], v[208:211]
  s_waitcnt lgkmcnt(6)
  v_and_b32 v216, v46, v3
  v_and_b32 v217, v46, v4
  v_and_b32 v218, v46, v5
  v_and_b32 v219, v46, v6
  s_nop 1
  v_mfma_f32_16x16x32_bf16 v[208:211], v[216:219], v[72:75], v[208:211]
  s_waitcnt lgkmcnt(5)
  v_and_b32 v220, v47, v3
  v_and_b32 v221, v47, v4
  v_and_b32 v222, v47, v5
  v_and_b32 v223, v47, v6
  s_nop 1
  v_mfma_f32_16x16x32_bf16 v[208:211], v[220:223], v[76:79], v[208:211]
  s_waitcnt lgkmcnt(4)
  v_and_b32 v216, v48, v3
  v_and_b32 v217, v48, v4
  v_and_b32 v218, v48, v5
  v_and_b32 v219, v48, v6
  s_nop 1
  v_mfma_f32_16x16x32_bf16 v[208:211], v[216:219], v[80:83], v[208:211]
  s_waitcnt lgkmcnt(3)
  v_and_b32 v220, v49, v3
  v_and_b32 v221, v49, v4
  v_and_b32 v222, v49, v5
  v_and_b32 v223, v49, v6
  s_nop 1
  v_mfma_f32_16x16x32_bf16 v[208:211], v[220:223], v[84:87], v[208:211]
  s_waitcnt lgkmcnt(2)
  v_and_b32 v216, v50, v3
  v_and_b32 v217, v50, v4
  v_and_b32 v218, v50, v5
  v_and_b32 v219, v50, v6
  s_nop 1
  v_mfma_f32_16x16x32_bf16 v[208:211], v[216:219], v[88:91], v[208:211]
  s_waitcnt lgkmcnt(1)
  v_and_b32 v220, v51, v3
  v_and_b32 v221, v51, v4
  v_and_b32 v222, v51, v5
  v_and_b32 v223, v51, v6
  s_nop 1
  v_mfma_f32_16x16x32_bf16 v[208:211], v[220:223], v[92:95], v[208:211]
  s_waitcnt lgkmcnt(0)
  v_and_b32 v216, v52, v3
  v_and_b32 v217, v52, v4
  v_and_b32 v218, v52, v5
  v_and_b32 v219, v52, v6
  s_nop 1
  v_mfma_f32_16x16x32_bf16 v[208:211], v[216:219], v[96:99], v[208:211]
  v_cmp_gt_u32 vcc, 9, v2
  v_cmp_gt_u32 s[4:5], 2, v1
  v_lshlrev_b32 v22, 5, v2
  v_lshl_add_u32 v22, v1, 4, v22
  s_mul_i32 s6, s3, 288
  s_and_b64 s[30:31], vcc, s[4:5]
  v_add_u32 v23, s6, v22
  s_mov_b64 exec, s[30:31]
  s_nop 2
  ds_write_b128 v23, v[208:211] offset:4672
  s_mov_b64 exec, 1
  ds_add_u32 v7, v21 offset:8
  s_mov_b64 exec, -1
  v_xor_b32 v22, v1, v2
  v_lshlrev_b32 v22, 4, v22
  v_lshl_add_u32 v22, v2, 8, v22
  s_lshl_b32 s5, s3, 14
  s_add_u32 s4, s5, 32768
  v_xor_b32 v23, 0, v22
  v_add_u32 v13, s4, v23
  v_xor_b32 v23, 64, v22
  v_add_u32 v14, s4, v23
  v_xor_b32 v23, 128, v22
  v_add_u32 v15, s4, v23
  v_xor_b32 v23, 192, v22
  v_add_u32 v16, s4, v23
  v_lshrrev_b32 v22, 2, v2
  v_and_b32 v23, 1, v1
  v_lshl_or_b32 v40, v23, 2, v22
  v_lshl_add_u32 v41, v23, 3, v22
  v_lshlrev_b32 v41, 8, v41
  v_lshrrev_b32 v23, 1, v1
  v_lshl_add_u32 v41, v23, 12, v41
  v_bfe_u32 v23, v2, 1, 1
  s_lshl_b32 s4, s3, 2
  v_add_u32 v23, s4, v23
  v_lshlrev_b32 v40, 1, v40
  v_xor_b32 v23, v23, v40
  v_lshl_add_u32 v41, v23, 4, v41
  v_and_b32 v23, 1, v2
  v_lshl_add_u32 v41, v23, 3, v41
  v_add_u32 v17, 98304, v41
  v_xor_b32 v41, 32, v41
  v_add_u32 v18, 98304, v41
  s_lshl_b32 s4, s3, 2
  v_add_u32 v22, s4, v1
  v_mul_u32_u24 v23, 144, v22
  v_lshl_add_u32 v23, v2, 4, v23
  v_add_u32 v19, 32768, v23
  v_lshlrev_b32 v53, 2, v22
  s_lshl_b32 s4, s3, 5
  v_lshrrev_b32 v22, 2, v2
  v_lshl_add_u32 v22, v1, 3, v22
  v_add_u32 v22, s4, v22
  v_mul_u32_u24 v22, 144, v22
  v_and_b32 v23, 3, v2
  v_lshl_add_u32 v22, v23, 3, v22
  v_add_u32 v54, 14080, v22
  s_mov_b32 s96, 0x7060500
  s_mov_b32 s97, 0x7060501
  s_mov_b32 s98, 0x7060502
  s_mov_b32 s99, 0x7060503
  s_mov_b32 s100, 0x0c0c0400
  s_mov_b32 s101, 0x04000c0c
  s_mov_b32 s63, 2000000
L_sp11:
  ds_read_b32 v8, v7 offset:24
  s_sub_u32 s63, s63, 1
  s_cbranch_scc1 L_spx12
  s_waitcnt lgkmcnt(0)
  v_readfirstlane_b32 s62, v8
  s_cmp_ge_u32 s62, 1
  s_cbranch_scc0 L_sp11
L_spx12:
  v_lshrrev_b32 v22, 3, v2
  v_lshlrev_b32 v22, 8, v22
  v_lshl_add_u32 v22, v1, 4, v22
  ds_read_b128 v[100:103], v22 offset:5824
  ds_read_b128 v[104:107], v22 offset:5888
  ds_read_b128 v[108:111], v22 offset:5952
  ds_read_b128 v[112:115], v22 offset:6016
  ds_read_b32 v20, v7 offset:48
  s_lshl_b32 s33, s3, 2
  s_add_u32 s32, s33, 91
  s_cmp_ge_u32 s65, s32
  s_cbranch_scc1 L_ppx14
  s_mov_b32 s63, 2000000
L_pp13:
  ds_read_b32 v8, v7 offset:11424
  s_sub_u32 s63, s63, 1
  s_cbranch_scc1 L_ppx14
  s_waitcnt lgkmcnt(0)
  v_readfirstlane_b32 s65, v8
  s_cmp_ge_u32 s65, s32
  s_cbranch_scc0 L_pp13
L_ppx14:
  s_waitcnt lgkmcnt(0)
  ds_read_b128 v[128:131], v13 offset:0
  ds_read_b128 v[132:135], v14 offset:0
  ds_read_b128 v[136:139], v15 offset:0
  ds_read_b128 v[140:143], v16 offset:0
  ds_read_b128 v[144:147], v13 offset:4096
  ds_read_b128 v[148:151], v14 offset:4096
  ds_read_b128 v[152:155], v15 offset:4096
  ds_read_b128 v[156:159], v16 offset:4096
  s_waitcnt lgkmcnt(4)
  v_mfma_f32_16x16x32_bf16 v[192:195], v[128:131], v[100:103], 0
  v_mfma_f32_16x16x32_bf16 v[192:195], v[132:135], v[104:107], v[192:195]
  v_mfma_f32_16x16x32_bf16 v[192:195], v[136:139], v[108:111], v[192:195]
  v_mfma_f32_16x16x32_bf16 v[192:195], v[140:143], v[112:115], v[192:195]
  ds_read_b128 v[160:163], v13 offset:8192
  ds_read_b128 v[164:167], v14 offset:8192
  ds_read_b128 v[168:171], v15 offset:8192
  ds_read_b128 v[172:175], v16 offset:8192
  s_waitcnt lgkmcnt(4)
  v_mfma_f32_16x16x32_bf16 v[196:199], v[144:147], v[100:103], 0
  v_mfma_f32_16x16x32_bf16 v[196:199], v[148:151], v[104:107], v[196:199]
  v_mfma_f32_16x16x32_bf16 v[196:199], v[152:155], v[108:111], v[196:199]
  v_mfma_f32_16x16x32_bf16 v[196:199], v[156:159], v[112:115], v[196:199]
  ds_read_b128 v[176:179], v13 offset:12288
  ds_read_b128 v[180:183], v14 offset:12288
  ds_read_b128 v[184:187], v15 offset:12288
  ds_read_b128 v[188:191], v16 offset:12288
  s_waitcnt lgkmcnt(4)
  v_mfma_f32_16x16x32_bf16 v[200:203], v[160:163], v[100:103], 0
  v_mfma_f32_16x16x32_bf16 v[200:203], v[164:167], v[104:107], v[200:203]
  v_mfma_f32_16x16x32_bf16 v[200:203], v[168:171], v[108:111], v[200:203]
  v_mfma_f32_16x16x32_bf16 v[200:203], v[172:175], v[112:115], v[200:203]
  s_waitcnt lgkmcnt(0)
  s_mov_b64 exec, 1
  ds_add_u32 v7, v21 offset:12
  s_mov_b64 exec, -1
  v_mfma_f32_16x16x32_bf16 v[204:207], v[176:179], v[100:103], 0
  v_mfma_f32_16x16x32_bf16 v[204:207], v[180:183], v[104:107], v[204:207]
  v_mfma_f32_16x16x32_bf16 v[204:207], v[184:187], v[108:111], v[204:207]
  v_mfma_f32_16x16x32_bf16 v[204:207], v[188:191], v[112:115], v[204:207]
  v_lshrrev_b32 v40, 3, v2
  v_lshlrev_b32 v41, 4, v40
  s_lshl_b32 s4, s3, 2
  v_add_u32 v42, s4, v41
  v_lshlrev_b32 v43, 9, v40
  v_lshl_add_u32 v43, v1, 3, v43
  s_lshl_b32 s4, s3, 7
  v_add_u32 v43, s4, v43
  s_nop 1
  v_cvt_pk_bf16_f32 v22, v192, v193
  v_lshlrev_b32 v192, 16, v22
  v_and_b32 v193, 0xffff0000, v22
  v_mul_f32 v192, 0x3db504f3, v192
  v_mul_f32 v193, 0x3db504f3, v193
  v_cvt_pk_bf16_f32 v22, v192, v193
  v_lshlrev_b32 v192, 16, v22
  v_and_b32 v193, 0xffff0000, v22
  v_cvt_pk_bf16_f32 v22, v194, v195
  v_lshlrev_b32 v194, 16, v22
  v_and_b32 v195, 0xffff0000, v22
  v_mul_f32 v194, 0x3db504f3, v194
  v_mul_f32 v195, 0x3db504f3, v195
  v_cvt_pk_bf16_f32 v22, v194, v195
  v_lshlrev_b32 v194, 16, v22
  v_and_b32 v195, 0xffff0000, v22
  v_cvt_pk_bf16_f32 v22, v196, v197
  v_lshlrev_b32 v196, 16, v22
  v_and_b32 v197, 0xffff0000, v22
  v_mul_f32 v196, 0x3db504f3, v196
  v_mul_f32 v197, 0x3db504f3, v197
  v_cvt_pk_bf16_f32 v22, v196, v197
  v_lshlrev_b32 v196, 16, v22
  v_and_b32 v197, 0xffff0000, v22
  v_cvt_pk_bf16_f32 v22, v198, v199
  v_lshlrev_b32 v198, 16, v22
  v_and_b32 v199, 0xffff0000, v22
  v_mul_f32 v198, 0x3db504f3, v198
  v_mul_f32 v199, 0x3db504f3, v199
  v_cvt_pk_bf16_f32 v22, v198, v199
  v_lshlrev_b32 v198, 16, v22
  v_and_b32 v199, 0xffff0000, v22
  v_cvt_pk_bf16_f32 v22, v200, v201
  v_lshlrev_b32 v200, 16, v22
  v_and_b32 v201, 0xffff0000, v22
  v_mul_f32 v200, 0x3db504f3, v200
  v_mul_f32 v201, 0x3db504f3, v201
  v_cvt_pk_bf16_f32 v22, v200, v201
  v_lshlrev_b32 v200, 16, v22
  v_and_b32 v201, 0xffff0000, v22
  v_cvt_pk_bf16_f32 v22, v202, v203
  v_lshlrev_b32 v202, 16, v22
  v_and_b32 v203, 0xffff0000, v22
  v_mul_f32 v202, 0x3db504f3, v202
  v_mul_f32 v203, 0x3db504f3, v203
  v_cvt_pk_bf16_f32 v22, v202, v203
  v_lshlrev_b32 v202, 16, v22
  v_and_b32 v203, 0xffff0000, v22
  v_cvt_pk_bf16_f32 v22, v204, v205
  v_lshlrev_b32 v204, 16, v22
  v_and_b32 v205, 0xffff0000, v22
  v_mul_f32 v204, 0x3db504f3, v204
  v_mul_f32 v205, 0x3db504f3, v205
  v_cvt_pk_bf16_f32 v22, v204, v205
  v_lshlrev_b32 v204, 16, v22
  v_and_b32 v205, 0xffff0000, v22
  v_cvt_pk_bf16_f32 v22, v206, v207
  v_lshlrev_b32 v206, 16, v22
  v_and_b32 v207, 0xffff0000, v22
  v_mul_f32 v206, 0x3db504f3, v206
  v_mul_f32 v207, 0x3db504f3, v207
  v_cvt_pk_bf16_f32 v22, v206, v207
  v_lshlrev_b32 v206, 16, v22
  v_and_b32 v207, 0xffff0000, v22
  v_max3_f32 v62, v192, v193, v194
  v_max3_f32 v62, v62, v195, v196
  v_max3_f32 v62, v62, v197, v198
  v_max3_f32 v62, v62, v199, v200
  v_max3_f32 v62, v62, v201, v202
  v_max3_f32 v62, v62, v203, v204
  v_max3_f32 v62, v62, v205, v206
  v_max_f32 v62, v62, v207
  v_mov_b32 v22, v62
  s_nop 1
  v_permlane16_swap_b32 v62, v22
  s_nop 0
  v_max_f32 v62, v62, v22
  v_mov_b32 v22, v62
  s_nop 1
  v_permlane32_swap_b32 v62, v22
  s_nop 0
  v_max_f32 v62, v62, v22
  s_mov_b64 exec, 0x101
  ds_write_b32 v42, v62 offset:8000
  s_mov_b64 exec, 1
  ds_add_u32 v7, v21 offset:0
  s_mov_b64 exec, -1
  s_mov_b32 s63, 2000000
L_sp15:
  ds_read_b32 v8, v7 offset:0
  s_sub_u32 s63, s63, 1
  s_cbranch_scc1 L_spx16
  s_waitcnt lgkmcnt(0)
  v_readfirstlane_b32 s62, v8
  s_cmp_ge_u32 s62, 4
  s_cbranch_scc0 L_sp15
L_spx16:
  ds_read_b128 v[56:59], v41 offset:8000
  s_waitcnt lgkmcnt(0)
  v_max3_f32 v62, v56, v57, v58
  v_max_f32 v62, v62, v59
  v_sub_f32 v192, v192, v62
  v_mul_f32 v192, 0x3fb8aa3b, v192
  v_exp_f32 v192, v192
  v_sub_f32 v193, v193, v62
  v_mul_f32 v193, 0x3fb8aa3b, v193
  v_exp_f32 v193, v193
  v_sub_f32 v194, v194, v62
  v_mul_f32 v194, 0x3fb8aa3b, v194
  v_exp_f32 v194, v194
  v_sub_f32 v195, v195, v62
  v_mul_f32 v195, 0x3fb8aa3b, v195
  v_exp_f32 v195, v195
  v_sub_f32 v196, v196, v62
  v_mul_f32 v196, 0x3fb8aa3b, v196
  v_exp_f32 v196, v196
  v_sub_f32 v197, v197, v62
  v_mul_f32 v197, 0x3fb8aa3b, v197
  v_exp_f32 v197, v197
  v_sub_f32 v198, v198, v62
  v_mul_f32 v198, 0x3fb8aa3b, v198
  v_exp_f32 v198, v198
  v_sub_f32 v199, v199, v62
  v_mul_f32 v199, 0x3fb8aa3b, v199
  v_exp_f32 v199, v199
  v_sub_f32 v200, v200, v62
  v_mul_f32 v200, 0x3fb8aa3b, v200
  v_exp_f32 v200, v200
  v_sub_f32 v201, v201, v62
  v_mul_f32 v201, 0x3fb8aa3b, v201
  v_exp_f32 v201, v201
  v_sub_f32 v202, v202, v62
  v_mul_f32 v202, 0x3fb8aa3b, v202
  v_exp_f32 v202, v202
  v_sub_f32 v203, v203, v62
  v_mul_f32 v203, 0x3fb8aa3b, v203
  v_exp_f32 v203, v203
  v_sub_f32 v204, v204, v62
  v_mul_f32 v204, 0x3fb8aa3b, v204
  v_exp_f32 v204, v204
  v_sub_f32 v205, v205, v62
  v_mul_f32 v205, 0x3fb8aa3b, v205
  v_exp_f32 v205, v205
  v_sub_f32 v206, v206, v62
  v_mul_f32 v206, 0x3fb8aa3b, v206
  v_exp_f32 v206, v206
  v_sub_f32 v207, v207, v62
  v_mul_f32 v207, 0x3fb8aa3b, v207
  v_exp_f32 v207, v207
  v_add_f32 v63, v192, v193
  v_add_f32 v63, v63, v194
  v_add_f32 v63, v63, v195
  v_add_f32 v63, v63, v196
  v_add_f32 v63, v63, v197
  v_add_f32 v63, v63, v198
  v_add_f32 v63, v63, v199
  v_add_f32 v63, v63, v200
  v_add_f32 v63, v63, v201
  v_add_f32 v63, v63, v202
  v_add_f32 v63, v63, v203
  v_add_f32 v63, v63, v204
  v_add_f32 v63, v63, v205
  v_add_f32 v63, v63, v206
  v_add_f32 v63, v63, v207
  v_cvt_pk_bf16_f32 v44, v192, v193
  v_cvt_pk_bf16_f32 v45, v194, v195
  v_cvt_pk_bf16_f32 v46, v196, v197
  v_cvt_pk_bf16_f32 v47, v198, v199
  v_cvt_pk_bf16_f32 v48, v200, v201
  v_cvt_pk_bf16_f32 v49, v202, v203
  v_cvt_pk_bf16_f32 v50, v204, v205
  v_cvt_pk_bf16_f32 v51, v206, v207
  v_mov_b32 v22, v63
  s_nop 1
  v_permlane16_swap_b32 v63, v22
  s_nop 0
  v_add_f32 v63, v63, v22
  v_mov_b32 v22, v63
  s_nop 1
  v_permlane32_swap_b32 v63, v22
  s_nop 0
  v_add_f32 v63, v63, v22
  s_mov_b32 exec_lo, 0x01010101
  s_mov_b32 exec_hi, 0x01010101
  ds_write_b64 v43, v[44:45] offset:6976
  ds_write_b64 v43, v[46:47] offset:7008
  ds_write_b64 v43, v[48:49] offset:7040
  ds_write_b64 v43, v[50:51] offset:7072
  s_mov_b64 exec, 0x101
  ds_write_b32 v42, v63 offset:8032
  s_mov_b64 exec, 1
  ds_add_u32 v7, v21 offset:32
  s_mov_b64 exec, -1
  v_and_b32 v22, 1, v2
  v_lshlrev_b32 v22, 13, v22
  v_bfe_u32 v23, v2, 1, 1
  v_lshl_add_u32 v22, v23, 10, v22
  v_lshl_add_u32 v22, v1, 8, v22
  s_lshl_b32 s4, s3, 11
  v_add_u32 v55, s4, v22
  s_lshl_b32 s34, s52, 14
  s_lshl_b32 s6, s53, 4
  s_add_u32 s34, s34, s6
  s_add_u32 s34, s34, 319488
  v_lshlrev_b32 v22, 2, v1
  v_add_u32 v22, v22, v2
  v_lshlrev_b32 v22, 4, v22
  s_lshl_b32 s4, s3, 8
  v_add_u32 v40, s4, v22
  v_and_b32 v22, 1, v2
  v_lshlrev_b32 v22, 9, v22
  v_lshl_add_u32 v41, v1, 4, v22
  s_mov_b32 s63, 2000000
L_sp17:
  ds_read_b32 v8, v7 offset:32
  s_sub_u32 s63, s63, 1
  s_cbranch_scc1 L_spx18
  s_waitcnt lgkmcnt(0)
  v_readfirstlane_b32 s62, v8
  s_cmp_ge_u32 s62, 4
  s_cbranch_scc0 L_sp17
L_spx18:
  ds_read_b128 v[128:131], v41 offset:6976
  ds_read_b128 v[132:135], v41 offset:7040
  ds_read_b128 v[136:139], v41 offset:7104
  ds_read_b128 v[140:143], v41 offset:7168
  ds_read_b128 v[144:147], v41 offset:7232
  ds_read_b128 v[148:151], v41 offset:7296
  ds_read_b128 v[152:155], v41 offset:7360
  ds_read_b128 v[156:159], v41 offset:7424
  s_cmp_lg_u32 s3, 0
  s_cbranch_scc1 L_noml
  v_lshrrev_b32 v22, 5, v0
  v_lshlrev_b32 v23, 4, v22
  ds_read_b128 v[56:59], v23 offset:8000
  ds_read_b128 v[60:63], v23 offset:8032
  v_lshlrev_b32 v22, 8, v22
  s_lshl_b32 s4, s52, 9
  s_lshl_b32 s6, s53, 4
  s_add_u32 s4, s4, s6
  s_add_u32 s4, s4, 581632
  s_waitcnt lgkmcnt(0)
  v_max3_f32 v56, v56, v57, v58
  v_max_f32 v56, v56, v59
  v_add_f32 v57, v60, v61
  v_add_f32 v58, v62, v63
  v_add_f32 v57, v57, v58
  v_mov_b32 v58, 0
  v_mov_b32 v59, 0
  v_perm_b32 v56, v56, v20, s96
  v_perm_b32 v57, v57, v20, s97
  v_perm_b32 v58, v58, v20, s98
  v_perm_b32 v59, v59, v20, s99
  s_mov_b32 exec_lo, 1
  s_mov_b32 exec_hi, 1
  buffer_store_dwordx4 v[56:59], v22, s[36:39], s4 offen
  ds_write_b128 v23, v[56:59] offset:9088
  s_mov_b64 exec, -1
L_noml:
  s_waitcnt lgkmcnt(0)
  s_cmp_ge_u32 s65, 111
  s_cbranch_scc1 L_ppx20
  s_mov_b32 s63, 2000000
L_pp19:
  ds_read_b32 v8, v7 offset:11424
  s_sub_u32 s63, s63, 1
  s_cbranch_scc1 L_ppx20
  s_waitcnt lgkmcnt(0)
  v_readfirstlane_b32 s65, v8
  s_cmp_ge_u32 s65, 111
  s_cbranch_scc0 L_pp19
L_ppx20:
  ds_read_b64_tr_b16 v[160:161], v17 offset:0
  ds_read_b64_tr_b16 v[162:163], v17 offset:1024
  ds_read_b64_tr_b16 v[164:165], v18 offset:0
  ds_read_b64_tr_b16 v[166:167], v18 offset:1024
  s_cmp_ge_u32 s65, 119
  s_cbranch_scc0 L_pvs21
  ds_read_b64_tr_b16 v[168:169], v17 offset:8192
  ds_read_b64_tr_b16 v[170:171], v17 offset:9216
  ds_read_b64_tr_b16 v[172:173], v18 offset:8192
  ds_read_b64_tr_b16 v[174:175], v18 offset:9216
  s_waitcnt lgkmcnt(4)
  v_mfma_f32_16x16x32_bf16 v[208:211], v[160:163], v[128:131], 0
  v_mfma_f32_16x16x32_bf16 v[212:215], v[164:167], v[128:131], 0
  s_branch L_pvn22
L_pvs21:
  s_waitcnt lgkmcnt(0)
  v_mfma_f32_16x16x32_bf16 v[208:211], v[160:163], v[128:131], 0
  v_mfma_f32_16x16x32_bf16 v[212:215], v[164:167], v[128:131], 0
  s_mov_b32 s63, 2000000
L_sw23:
  ds_read_b32 v8, v7 offset:11424
  ds_read_b64_tr_b16 v[168:169], v17 offset:8192
  ds_read_b64_tr_b16 v[170:171], v17 offset:9216
  ds_read_b64_tr_b16 v[172:173], v18 offset:8192
  ds_read_b64_tr_b16 v[174:175], v18 offset:9216
  s_sub_u32 s63, s63, 1
  s_cbranch_scc1 L_swx24
  s_waitcnt lgkmcnt(0)
  v_readfirstlane_b32 s65, v8
  s_cmp_ge_u32 s65, 119
  s_cbranch_scc0 L_sw23
L_swx24:
  s_waitcnt lgkmcnt(0)
L_pvn22:
  s_cmp_ge_u32 s65, 127
  s_cbranch_scc0 L_pvs25
  ds_read_b64_tr_b16 v[160:161], v17 offset:16384
  ds_read_b64_tr_b16 v[162:163], v17 offset:17408
  ds_read_b64_tr_b16 v[164:165], v18 offset:16384
  ds_read_b64_tr_b16 v[166:167], v18 offset:17408
  s_waitcnt lgkmcnt(4)
  v_mfma_f32_16x16x32_bf16 v[208:211], v[168:171], v[132:135], v[208:211]
  v_mfma_f32_16x16x32_bf16 v[212:215], v[172:175], v[132:135], v[212:215]
  s_branch L_pvn26
L_pvs25:
  s_waitcnt lgkmcnt(0)
  v_mfma_f32_16x16x32_bf16 v[208:211], v[168:171], v[132:135], v[208:211]
  v_mfma_f32_16x16x32_bf16 v[212:215], v[172:175], v[132:135], v[212:215]
  s_mov_b32 s63, 2000000
L_sw27:
  ds_read_b32 v8, v7 offset:11424
  ds_read_b64_tr_b16 v[160:161], v17 offset:16384
  ds_read_b64_tr_b16 v[162:163], v17 offset:17408
  ds_read_b64_tr_b16 v[164:165], v18 offset:16384
  ds_read_b64_tr_b16 v[166:167], v18 offset:17408
  s_sub_u32 s63, s63, 1
  s_cbranch_scc1 L_swx28
  s_waitcnt lgkmcnt(0)
  v_readfirstlane_b32 s65, v8
  s_cmp_ge_u32 s65, 127
  s_cbranch_scc0 L_sw27
L_swx28:
  s_waitcnt lgkmcnt(0)
L_pvn26:
  s_cmp_ge_u32 s65, 135
  s_cbranch_scc0 L_pvs29
  ds_read_b64_tr_b16 v[168:169], v17 offset:24576
  ds_read_b64_tr_b16 v[170:171], v17 offset:25600
  ds_read_b64_tr_b16 v[172:173], v18 offset:24576
  ds_read_b64_tr_b16 v[174:175], v18 offset:25600
  s_waitcnt lgkmcnt(4)
  v_mfma_f32_16x16x32_bf16 v[208:211], v[160:163], v[136:139], v[208:211]
  v_mfma_f32_16x16x32_bf16 v[212:215], v[164:167], v[136:139], v[212:215]
  s_branch L_pvn30
L_pvs29:
  s_waitcnt lgkmcnt(0)
  v_mfma_f32_16x16x32_bf16 v[208:211], v[160:163], v[136:139], v[208:211]
  v_mfma_f32_16x16x32_bf16 v[212:215], v[164:167], v[136:139], v[212:215]
  s_mov_b32 s63, 2000000
L_sw31:
  ds_read_b32 v8, v7 offset:11424
  ds_read_b64_tr_b16 v[168:169], v17 offset:24576
  ds_read_b64_tr_b16 v[170:171], v17 offset:25600
  ds_read_b64_tr_b16 v[172:173], v18 offset:24576
  ds_read_b64_tr_b16 v[174:175], v18 offset:25600
  s_sub_u32 s63, s63, 1
  s_cbranch_scc1 L_swx32
  s_waitcnt lgkmcnt(0)
  v_readfirstlane_b32 s65, v8
  s_cmp_ge_u32 s65, 135
  s_cbranch_scc0 L_sw31
L_swx32:
  s_waitcnt lgkmcnt(0)
L_pvn30:
  s_cmp_ge_u32 s65, 143
  s_cbranch_scc0 L_pvs33
  ds_read_b64_tr_b16 v[160:161], v17 offset:32768
  ds_read_b64_tr_b16 v[162:163], v17 offset:33792
  ds_read_b64_tr_b16 v[164:165], v18 offset:32768
  ds_read_b64_tr_b16 v[166:167], v18 offset:33792
  s_waitcnt lgkmcnt(4)
  v_mfma_f32_16x16x32_bf16 v[208:211], v[168:171], v[140:143], v[208:211]
  v_mfma_f32_16x16x32_bf16 v[212:215], v[172:175], v[140:143], v[212:215]
  s_branch L_pvn34
L_pvs33:
  s_waitcnt lgkmcnt(0)
  v_mfma_f32_16x16x32_bf16 v[208:211], v[168:171], v[140:143], v[208:211]
  v_mfma_f32_16x16x32_bf16 v[212:215], v[172:175], v[140:143], v[212:215]
  s_mov_b32 s63, 2000000
L_sw35:
  ds_read_b32 v8, v7 offset:11424
  ds_read_b64_tr_b16 v[160:161], v17 offset:32768
  ds_read_b64_tr_b16 v[162:163], v17 offset:33792
  ds_read_b64_tr_b16 v[164:165], v18 offset:32768
  ds_read_b64_tr_b16 v[166:167], v18 offset:33792
  s_sub_u32 s63, s63, 1
  s_cbranch_scc1 L_swx36
  s_waitcnt lgkmcnt(0)
  v_readfirstlane_b32 s65, v8
  s_cmp_ge_u32 s65, 143
  s_cbranch_scc0 L_sw35
L_swx36:
  s_waitcnt lgkmcnt(0)
L_pvn34:
  s_cmp_ge_u32 s65, 151
  s_cbranch_scc0 L_pvs37
  ds_read_b64_tr_b16 v[168:169], v17 offset:40960
  ds_read_b64_tr_b16 v[170:171], v17 offset:41984
  ds_read_b64_tr_b16 v[172:173], v18 offset:40960
  ds_read_b64_tr_b16 v[174:175], v18 offset:41984
  s_waitcnt lgkmcnt(4)
  v_mfma_f32_16x16x32_bf16 v[208:211], v[160:163], v[144:147], v[208:211]
  v_mfma_f32_16x16x32_bf16 v[212:215], v[164:167], v[144:147], v[212:215]
  s_branch L_pvn38
L_pvs37:
  s_waitcnt lgkmcnt(0)
  v_mfma_f32_16x16x32_bf16 v[208:211], v[160:163], v[144:147], v[208:211]
  v_mfma_f32_16x16x32_bf16 v[212:215], v[164:167], v[144:147], v[212:215]
  s_mov_b32 s63, 2000000
L_sw39:
  ds_read_b32 v8, v7 offset:11424
  ds_read_b64_tr_b16 v[168:169], v17 offset:40960
  ds_read_b64_tr_b16 v[170:171], v17 offset:41984
  ds_read_b64_tr_b16 v[172:173], v18 offset:40960
  ds_read_b64_tr_b16 v[174:175], v18 offset:41984
  s_sub_u32 s63, s63, 1
  s_cbranch_scc1 L_swx40
  s_waitcnt lgkmcnt(0)
  v_readfirstlane_b32 s65, v8
  s_cmp_ge_u32 s65, 151
  s_cbranch_scc0 L_sw39
L_swx40:
  s_waitcnt lgkmcnt(0)
L_pvn38:
  s_cmp_ge_u32 s65, 159
  s_cbranch_scc0 L_pvs41
  ds_read_b64_tr_b16 v[160:161], v17 offset:49152
  ds_read_b64_tr_b16 v[162:163], v17 offset:50176
  ds_read_b64_tr_b16 v[164:165], v18 offset:49152
  ds_read_b64_tr_b16 v[166:167], v18 offset:50176
  s_waitcnt lgkmcnt(4)
  v_mfma_f32_16x16x32_bf16 v[208:211], v[168:171], v[148:151], v[208:211]
  v_mfma_f32_16x16x32_bf16 v[212:215], v[172:175], v[148:151], v[212:215]
  s_branch L_pvn42
L_pvs41:
  s_waitcnt lgkmcnt(0)
  v_mfma_f32_16x16x32_bf16 v[208:211], v[168:171], v[148:151], v[208:211]
  v_mfma_f32_16x16x32_bf16 v[212:215], v[172:175], v[148:151], v[212:215]
  s_mov_b32 s63, 2000000
L_sw43:
  ds_read_b32 v8, v7 offset:11424
  ds_read_b64_tr_b16 v[160:161], v17 offset:49152
  ds_read_b64_tr_b16 v[162:163], v17 offset:50176
  ds_read_b64_tr_b16 v[164:165], v18 offset:49152
  ds_read_b64_tr_b16 v[166:167], v18 offset:50176
  s_sub_u32 s63, s63, 1
  s_cbranch_scc1 L_swx44
  s_waitcnt lgkmcnt(0)
  v_readfirstlane_b32 s65, v8
  s_cmp_ge_u32 s65, 159
  s_cbranch_scc0 L_sw43
L_swx44:
  s_waitcnt lgkmcnt(0)
L_pvn42:
  s_cmp_ge_u32 s65, 167
  s_cbranch_scc0 L_pvs45
  ds_read_b64_tr_b16 v[168:169], v17 offset:57344
  ds_read_b64_tr_b16 v[170:171], v17 offset:58368
  ds_read_b64_tr_b16 v[172:173], v18 offset:57344
  ds_read_b64_tr_b16 v[174:175], v18 offset:58368
  s_waitcnt lgkmcnt(4)
  v_mfma_f32_16x16x32_bf16 v[208:211], v[160:163], v[152:155], v[208:211]
  v_mfma_f32_16x16x32_bf16 v[212:215], v[164:167], v[152:155], v[212:215]
  s_branch L_pvn46
L_pvs45:
  s_waitcnt lgkmcnt(0)
  v_mfma_f32_16x16x32_bf16 v[208:211], v[160:163], v[152:155], v[208:211]
  v_mfma_f32_16x16x32_bf16 v[212:215], v[164:167], v[152:155], v[212:215]
  s_mov_b32 s63, 2000000
L_sw47:
  ds_read_b32 v8, v7 offset:11424
  ds_read_b64_tr_b16 v[168:169], v17 offset:57344
  ds_read_b64_tr_b16 v[170:171], v17 offset:58368
  ds_read_b64_tr_b16 v[172:173], v18 offset:57344
  ds_read_b64_tr_b16 v[174:175], v18 offset:58368
  s_sub_u32 s63, s63, 1
  s_cbranch_scc1 L_swx48
  s_waitcnt lgkmcnt(0)
  v_readfirstlane_b32 s65, v8
  s_cmp_ge_u32 s65, 167
  s_cbranch_scc0 L_sw47
L_swx48:
  s_waitcnt lgkmcnt(0)
L_pvn46:
  s_waitcnt lgkmcnt(2)
  v_mfma_f32_16x16x32_bf16 v[208:211], v[168:171], v[156:159], v[208:211]
  s_waitcnt lgkmcnt(0)
  v_mfma_f32_16x16x32_bf16 v[212:215], v[172:175], v[156:159], v[212:215]
  s_mov_b32 s4, 0xcccccccc
  s_mov_b32 s5, 0xcccccccc
  s_nop 5
  v_cndmask_b32 v208, v208, v212, s[4:5]
  v_cndmask_b32 v209, v209, v213, s[4:5]
  v_cndmask_b32 v210, v210, v214, s[4:5]
  v_cndmask_b32 v211, v211, v215, s[4:5]
  v_perm_b32 v208, v208, v20, s96
  v_perm_b32 v209, v209, v20, s97
  v_perm_b32 v210, v210, v20, s98
  v_perm_b32 v211, v211, v20, s99
  s_mov_b32 exec_lo, 0x000f000f
  s_mov_b32 exec_hi, 0x000f000f
  buffer_store_dwordx4 v[208:211], v55, s[36:39], s34 offen
  ds_write_b128 v40, v[208:211] offset:8064
  s_mov_b64 exec, 1
  ds_add_u32 v7, v21 offset:16
  s_mov_b64 exec, -1
  v_and_b32 v22, 7, v0
  v_lshrrev_b32 v23, 3, v0
  v_lshlrev_b32 v42, 8, v23
  v_lshl_add_u32 v42, v22, 4, v42
  v_lshlrev_b32 v43, 4, v2
  s_lshl_b32 s4, s54, 8
  s_add_u32 s4, s4, 581632
  s_lshl_b32 s6, s54, 13
  s_lshl_b32 s7, s3, 11
  s_add_u32 s6, s6, s7
  s_add_u32 s6, s6, 319488
  s_mov_b32 s5, 0
  s_mov_b32 s40, 0xff00ff00
  s_mov_b32 s41, 0xff00ff00
  s_mov_b32 s35, 0
L_mlpoll:
  buffer_load_dwordx4 v[108:111], v43, s[36:39], s4 offen sc1
  s_mov_b32 s63, 2000000
L_sp49:
  ds_read_b32 v8, v7 offset:28
  s_sub_u32 s63, s63, 1
  s_cbranch_scc1 L_spx50
  s_waitcnt lgkmcnt(0)
  v_readfirstlane_b32 s62, v8
  s_cmp_ge_u32 s62, 1
  s_cbranch_scc0 L_sp49
L_spx50:
  ds_read_b32 v44, v53 offset:6336
  ds_read_b32 v45, v53 offset:6400
  ds_read_b32 v46, v53 offset:6464
  ds_read_b32 v47, v53 offset:6528
  ds_read_b32 v48, v53 offset:6592
  ds_read_b32 v49, v53 offset:6656
  ds_read_b32 v50, v53 offset:6720
  ds_read_b32 v51, v53 offset:6784
  ds_read_b32 v52, v53 offset:6848
  s_waitcnt lgkmcnt(0)
  v_and_b32 v216, v44, v3
  v_and_b32 v217, v44, v4
  v_and_b32 v218, v44, v5
  v_and_b32 v219, v44, v6
  v_and_b32 v220, v45, v3
  v_and_b32 v221, v45, v4
  v_and_b32 v222, v45, v5
  v_and_b32 v223, v45, v6
  v_and_b32 v224, v46, v3
  v_and_b32 v225, v46, v4
  v_and_b32 v226, v46, v5
  v_and_b32 v227, v46, v6
  v_and_b32 v228, v47, v3
  v_and_b32 v229, v47, v4
  v_and_b32 v230, v47, v5
  v_and_b32 v231, v47, v6
  v_and_b32 v232, v48, v3
  v_and_b32 v233, v48, v4
  v_and_b32 v234, v48, v5
  v_and_b32 v235, v48, v6
  v_and_b32 v236, v49, v3
  v_and_b32 v237, v49, v4
  v_and_b32 v238, v49, v5
  v_and_b32 v239, v49, v6
  v_and_b32 v240, v50, v3
  v_and_b32 v241, v50, v4
  v_and_b32 v242, v50, v5
  v_and_b32 v243, v50, v6
  v_and_b32 v244, v51, v3
  v_and_b32 v245, v51, v4
  v_and_b32 v246, v51, v5
  v_and_b32 v247, v51, v6
  v_and_b32 v248, v52, v3
  v_and_b32 v249, v52, v4
  v_and_b32 v250, v52, v5
  v_and_b32 v251, v52, v6
  s_waitcnt vmcnt(0)
  v_perm_b32 v22, v109, v108, s100
  v_perm_b32 v23, v111, v110, s101
  v_or_b32 v22, v22, v23
  v_cmp_ne_u32 vcc, v22, v20
  s_cbranch_vccz L_mldone
L_mlloop:
  s_add_u32 s35, s35, 1
  s_sub_i32 s32, s35, 6
  s_bitcmp1_b32 s32, 0
  s_cselect_b32 s32, -1, 1
  s_mul_i32 s32, s32, 589824
  s_cmp_lt_u32 s35, 6
  s_cselect_b32 s32, 0, s32
  s_add_u32 s4, s4, s32
  s_cmp_gt_u32 s35, 200000
  s_cbranch_scc1 L_mldone
  buffer_load_dwordx4 v[108:111], v43, s[36:39], s4 offen sc1
  s_waitcnt vmcnt(0)
  v_perm_b32 v22, v109, v108, s100
  v_perm_b32 v23, v111, v110, s101
  v_or_b32 v22, v22, v23
  v_cmp_ne_u32 vcc, v22, v20
  s_cbranch_vccnz L_mlloop
L_mldone:
  v_and_b32 v108, 0xffffff00, v108
  v_and_b32 v109, 0xffffff00, v109
  v_mov_b32 v112, v108
  s_nop 1
  v_max_f32_dpp v112, v112, v112 quad_perm:[1,0,3,2] row_mask:0xf bank_mask:0xf
  s_nop 1
  v_max_f32_dpp v112, v112, v112 quad_perm:[2,3,0,1] row_mask:0xf bank_mask:0xf
  s_nop 1
  v_max_f32_dpp v112, v112, v112 row_half_mirror row_mask:0xf bank_mask:0xf
  s_nop 1
  v_max_f32_dpp v112, v112, v112 row_mirror row_mask:0xf bank_mask:0xf
  v_sub_f32 v113, v108, v112
  v_mul_f32 v113, 0x3fb8aa3b, v113
  v_exp_f32 v113, v113
  s_nop 0
  v_mul_f32 v114, v113, v109
  s_nop 1
  v_add_f32_dpp v114, v114, v114 quad_perm:[1,0,3,2] row_mask:0xf bank_mask:0xf
  s_nop 1
  v_add_f32_dpp v114, v114, v114 quad_perm:[2,3,0,1] row_mask:0xf bank_mask:0xf
  s_nop 1
  v_add_f32_dpp v114, v114, v114 row_half_mirror row_mask:0xf bank_mask:0xf
  s_nop 1
  v_add_f32_dpp v114, v114, v114 row_mirror row_mask:0xf bank_mask:0xf
  v_rcp_f32 v114, v114
  s_nop 0
  v_mul_f32 v113, v113, v114
  s_nop 1
  v_mov_b32_dpp v114, v113 row_ror:8 row_mask:0xf bank_mask:0xf
  v_cndmask_b32 v112, v113, v114, s[40:41]
  v_cndmask_b32 v113, v114, v113, s[40:41]
  s_cmp_ge_u32 s65, 186
  s_cbranch_scc1 L_ppx52
  s_mov_b32 s63, 2000000
L_pp51:
  ds_read_b32 v8, v7 offset:11424
  s_sub_u32 s63, s63, 1
  s_cbranch_scc1 L_ppx52
  s_waitcnt lgkmcnt(0)
  v_readfirstlane_b32 s65, v8
  s_cmp_ge_u32 s65, 186
  s_cbranch_scc0 L_pp51
L_ppx52:
  ds_read_b64_tr_b16 v[64:65], v54 offset:0
  ds_read_b64_tr_b16 v[66:67], v54 offset:576
  ds_read_b64_tr_b16 v[68:69], v54 offset:32
  ds_read_b64_tr_b16 v[70:71], v54 offset:608
  ds_read_b64_tr_b16 v[72:73], v54 offset:64
  ds_read_b64_tr_b16 v[74:75], v54 offset:640
  ds_read_b64_tr_b16 v[76:77], v54 offset:96
  ds_read_b64_tr_b16 v[78:79], v54 offset:672
  ds_read_b64_tr_b16 v[80:81], v54 offset:128
  ds_read_b64_tr_b16 v[82:83], v54 offset:704
  s_mov_b32 s63, 2000000
L_sp53:
  ds_read_b32 v8, v7 offset:36
  s_sub_u32 s63, s63, 1
  s_cbranch_scc1 L_spx54
  s_waitcnt lgkmcnt(0)
  v_readfirstlane_b32 s62, v8
  s_cmp_ge_u32 s62, 1
  s_cbranch_scc0 L_sp53
L_spx54:
  buffer_load_dwordx4 v[100:103], v42, s[36:39], s6 offen sc1
  buffer_load_dwordx4 v[104:107], v42, s[36:39], s6 offen offset:128 sc1
  s_cmp_ge_u32 s65, 200
  s_cbranch_scc1 L_ppx56
  s_mov_b32 s63, 2000000
L_pp55:
  ds_read_b32 v8, v7 offset:11424
  s_sub_u32 s63, s63, 1
  s_cbranch_scc1 L_ppx56
  s_waitcnt lgkmcnt(0)
  v_readfirstlane_b32 s65, v8
  s_cmp_ge_u32 s65, 200
  s_cbranch_scc0 L_pp55
L_ppx56:
  ds_read_b128 v[128:131], v19 offset:0
  ds_read_b128 v[132:135], v19 offset:2304
  ds_read_b128 v[136:139], v19 offset:4608
  ds_read_b128 v[140:143], v19 offset:6912
  ds_read_b128 v[144:147], v19 offset:9216
  ds_read_b128 v[148:151], v19 offset:11520
  s_waitcnt lgkmcnt(5)
  v_mfma_f32_16x16x32_bf16 v[184:187], v[216:219], v[128:131], 0
  s_waitcnt lgkmcnt(4)
  v_mfma_f32_16x16x32_bf16 v[184:187], v[220:223], v[132:135], v[184:187]
  s_waitcnt lgkmcnt(3)
  v_mfma_f32_16x16x32_bf16 v[184:187], v[224:227], v[136:139], v[184:187]
  s_waitcnt lgkmcnt(2)
  v_mfma_f32_16x16x32_bf16 v[184:187], v[228:231], v[140:143], v[184:187]
  s_waitcnt lgkmcnt(1)
  v_mfma_f32_16x16x32_bf16 v[184:187], v[232:235], v[144:147], v[184:187]
  s_waitcnt lgkmcnt(0)
  v_mfma_f32_16x16x32_bf16 v[184:187], v[236:239], v[148:151], v[184:187]
  s_cmp_ge_u32 s65, 205
  s_cbranch_scc1 L_ppx58
  s_mov_b32 s63, 2000000
L_pp57:
  ds_read_b32 v8, v7 offset:11424
  s_sub_u32 s63, s63, 1
  s_cbranch_scc1 L_ppx58
  s_waitcnt lgkmcnt(0)
  v_readfirstlane_b32 s65, v8
  s_cmp_ge_u32 s65, 205
  s_cbranch_scc0 L_pp57
L_ppx58:
  ds_read_b128 v[152:155], v19 offset:13824
  ds_read_b128 v[156:159], v19 offset:16128
  s_waitcnt lgkmcnt(1)
  v_mfma_f32_16x16x32_bf16 v[184:187], v[240:243], v[152:155], v[184:187]
  s_waitcnt lgkmcnt(0)
  v_mfma_f32_16x16x32_bf16 v[184:187], v[244:247], v[156:159], v[184:187]
  s_mov_b32 s63, 2000000
L_sw59:
  ds_read_b32 v8, v7 offset:11424
  ds_read_b128 v[160:163], v19 offset:18432
  s_sub_u32 s63, s63, 1
  s_cbranch_scc1 L_swx60
  s_waitcnt lgkmcnt(0)
  v_readfirstlane_b32 s65, v8
  s_cmp_ge_u32 s65, 207
  s_cbranch_scc0 L_sw59
L_swx60:
  s_waitcnt lgkmcnt(0)
  v_mfma_f32_16x16x32_bf16 v[184:187], v[248:251], v[160:163], v[184:187]
  s_mul_i32 s32, s3, 576
  v_lshlrev_b32 v23, 5, v2
  v_lshl_add_u32 v23, v1, 4, v23
  v_add_u32 v23, s32, v23
  s_mov_b64 exec, s[30:31]
  s_nop 3
  ds_write_b128 v23, v[184:187] offset:9408
  s_mov_b64 exec, -1
L_ocheck:
  s_waitcnt vmcnt(0)
  v_perm_b32 v22, v101, v100, s100
  v_perm_b32 v23, v103, v102, s101
  v_or_b32 v22, v22, v23
  v_cmp_ne_u32 vcc, v22, v20
  v_perm_b32 v22, v105, v104, s100
  v_perm_b32 v23, v107, v106, s101
  v_or_b32 v22, v22, v23
  v_cmp_ne_u32 s[14:15], v22, v20
  s_or_b64 vcc, vcc, s[14:15]
  s_cbranch_vccz L_odone
  s_add_u32 s5, s5, 1
  s_sub_i32 s32, s5, 6
  s_bitcmp1_b32 s32, 0
  s_cselect_b32 s32, -1, 1
  s_mul_i32 s32, s32, 589824
  s_cmp_lt_u32 s5, 6
  s_cselect_b32 s32, 0, s32
  s_add_u32 s6, s6, s32
  s_cmp_gt_u32 s5, 200000
  s_cbranch_scc1 L_odone
  buffer_load_dwordx4 v[100:103], v42, s[36:39], s6 offen sc1
  buffer_load_dwordx4 v[104:107], v42, s[36:39], s6 offen offset:128 sc1
  s_branch L_ocheck
L_odone:
  s_movk_i32 s32, 0xff00
  v_and_b32 v100, s32, v100
  v_and_b32 v101, s32, v101
  v_and_b32 v102, s32, v102
  v_and_b32 v103, s32, v103
  v_and_b32 v104, s32, v104
  v_and_b32 v105, s32, v105
  v_and_b32 v106, s32, v106
  v_and_b32 v107, s32, v107
  v_mul_f32 v100, v112, v100
  v_mul_f32 v101, v112, v101
  v_mul_f32 v102, v112, v102
  v_mul_f32 v103, v112, v103
  v_fmac_f32 v100, v113, v104
  v_fmac_f32 v101, v113, v105
  v_fmac_f32 v102, v113, v106
  v_fmac_f32 v103, v113, v107
  v_add_f32_dpp v100, v100, v100 quad_perm:[1,0,3,2] row_mask:0xf bank_mask:0xf
  v_add_f32_dpp v101, v101, v101 quad_perm:[1,0,3,2] row_mask:0xf bank_mask:0xf
  v_add_f32_dpp v102, v102, v102 quad_perm:[1,0,3,2] row_mask:0xf bank_mask:0xf
  v_add_f32_dpp v103, v103, v103 quad_perm:[1,0,3,2] row_mask:0xf bank_mask:0xf
  v_add_f32_dpp v100, v100, v100 quad_perm:[2,3,0,1] row_mask:0xf bank_mask:0xf
  v_add_f32_dpp v101, v101, v101 quad_perm:[2,3,0,1] row_mask:0xf bank_mask:0xf
  v_add_f32_dpp v102, v102, v102 quad_perm:[2,3,0,1] row_mask:0xf bank_mask:0xf
  v_add_f32_dpp v103, v103, v103 quad_perm:[2,3,0,1] row_mask:0xf bank_mask:0xf
  v_add_f32_dpp v100, v100, v100 row_half_mirror row_mask:0xf bank_mask:0xf
  v_add_f32_dpp v101, v101, v101 row_half_mirror row_mask:0xf bank_mask:0xf
  v_add_f32_dpp v102, v102, v102 row_half_mirror row_mask:0xf bank_mask:0xf
  v_add_f32_dpp v103, v103, v103 row_half_mirror row_mask:0xf bank_mask:0xf
  v_cvt_pk_bf16_f32 v104, v100, v101
  v_cvt_pk_bf16_f32 v105, v102, v103
  s_nop 0
  v_mov_b32_dpp v116, v104 row_newbcast:0 row_mask:0xf bank_mask:0xf
  v_mov_b32_dpp v117, v105 row_newbcast:0 row_mask:0xf bank_mask:0xf
  v_mov_b32_dpp v118, v104 row_newbcast:8 row_mask:0xf bank_mask:0xf
  v_mov_b32_dpp v119, v105 row_newbcast:8 row_mask:0xf bank_mask:0xf
  s_mul_i32 s6, s3, 576
  v_lshlrev_b32 v22, 4, v1
  v_add_u32 v22, s6, v22
  s_waitcnt lgkmcnt(0)
  v_mfma_f32_16x16x32_bf16 v[164:167], v[64:67], v[116:119], 0
  v_mfma_f32_16x16x32_bf16 v[168:171], v[68:71], v[116:119], 0
  v_mfma_f32_16x16x32_bf16 v[172:175], v[72:75], v[116:119], 0
  v_mfma_f32_16x16x32_bf16 v[176:179], v[76:79], v[116:119], 0
  v_mfma_f32_16x16x32_bf16 v[180:183], v[80:83], v[116:119], 0
  s_mov_b32 exec_lo, 0x00010001
  s_mov_b32 exec_hi, 0x00010001
  s_nop 1
  ds_write_b128 v22, v[164:167] offset:9120
  ds_write_b128 v22, v[168:171] offset:9184
  ds_write_b128 v22, v[172:175] offset:9248
  ds_write_b128 v22, v[176:179] offset:9312
  s_mov_b32 exec_hi, 0
  ds_write_b128 v22, v[180:183] offset:9376
  s_mov_b64 exec, -1
  s_mov_b64 exec, 1
  ds_add_u32 v7, v21 offset:20
  s_mov_b64 exec, -1
  s_cmp_lg_u32 s3, 1
  s_cbranch_scc1 L_fin_stamps
  s_cmp_ge_u32 s2, 72
  s_cbranch_scc1 L_fin_stamps
  s_waitcnt lgkmcnt(0)
  s_mov_b32 s46, 1152
  s_mov_b32 s47, 0x20000
  s_mov_b32 s50, 1152
  s_mov_b32 s51, 0x20000
  s_mul_i32 s4, s2, 7282
  s_lshr_b32 s4, s4, 16
  s_mul_i32 s5, s4, 9
  s_sub_u32 s5, s2, s5
  s_lshl_b32 s5, s5, 1
  s_mul_i32 s4, s4, 12288
  s_lshl_b32 s5, s5, 4
  s_add_u32 s4, s4, s5
  s_add_u32 s4, s4, 1245184
  v_and_b32 v42, 31, v0
  v_mul_u32_u24 v42, 384, v42
  v_lshrrev_b32 v43, 5, v0
  v_lshl_add_u32 v42, v43, 4, v42
  v_and_b32 v43, 3, v0
  v_lshlrev_b32 v43, 1, v43
  v_lshrrev_b32 v74, 5, v0
  v_lshl_add_u32 v43, v74, 3, v43
  s_lshl_b32 s5, s2, 4
  v_add_u32 v43, s5, v43
  buffer_load_ushort v72, v43, s[8:11], 0 offen
  buffer_load_ushort v73, v43, s[44:47], 0 offen
  v_and_b32 v74, 1, v0
  v_cmp_eq_u32 s[6:7], 1, v74
  v_and_b32 v74, 2, v0
  v_cmp_eq_u32 s[40:41], 2, v74
  s_mov_b32 s5, 0
L_fpoll:
  buffer_load_dwordx4 v[64:67], v42, s[36:39], s4 offen sc1
  s_waitcnt vmcnt(0)
  v_perm_b32 v22, v65, v64, s100
  v_perm_b32 v23, v67, v66, s101
  v_or_b32 v22, v22, v23
  v_cmp_ne_u32 vcc, v22, v20
  s_add_u32 s5, s5, 1
  s_cmp_gt_u32 s5, 200000
  s_cbranch_scc1 L_fdone
  s_and_b64 exec, exec, vcc
  s_cbranch_execnz L_fpoll
L_fdone:
  s_mov_b64 exec, -1
  s_movk_i32 s32, 0xff00
  v_and_b32 v64, s32, v64
  v_and_b32 v65, s32, v65
  v_and_b32 v66, s32, v66
  v_and_b32 v67, s32, v67
  v_add_f32_dpp v64, v64, v64 quad_perm:[1,0,3,2] row_mask:0xf bank_mask:0xf
  v_add_f32_dpp v65, v65, v65 quad_perm:[1,0,3,2] row_mask:0xf bank_mask:0xf
  v_add_f32_dpp v66, v66, v66 quad_perm:[1,0,3,2] row_mask:0xf bank_mask:0xf
  v_add_f32_dpp v67, v67, v67 quad_perm:[1,0,3,2] row_mask:0xf bank_mask:0xf
  s_nop 0
  v_add_f32_dpp v64, v64, v64 quad_perm:[2,3,0,1] row_mask:0xf bank_mask:0xf
  v_add_f32_dpp v65, v65, v65 quad_perm:[2,3,0,1] row_mask:0xf bank_mask:0xf
  v_add_f32_dpp v66, v66, v66 quad_perm:[2,3,0,1] row_mask:0xf bank_mask:0xf
  v_add_f32_dpp v67, v67, v67 quad_perm:[2,3,0,1] row_mask:0xf bank_mask:0xf
  s_nop 0
  v_add_f32_dpp v64, v64, v64 row_half_mirror row_mask:0xf bank_mask:0xf
  v_add_f32_dpp v65, v65, v65 row_half_mirror row_mask:0xf bank_mask:0xf
  v_add_f32_dpp v66, v66, v66 row_half_mirror row_mask:0xf bank_mask:0xf
  v_add_f32_dpp v67, v67, v67 row_half_mirror row_mask:0xf bank_mask:0xf
  s_nop 0
  v_add_f32_dpp v64, v64, v64 row_mirror row_mask:0xf bank_mask:0xf
  v_add_f32_dpp v65, v65, v65 row_mirror row_mask:0xf bank_mask:0xf
  v_add_f32_dpp v66, v66, v66 row_mirror row_mask:0xf bank_mask:0xf
  v_add_f32_dpp v67, v67, v67 row_mirror row_mask:0xf bank_mask:0xf
  s_nop 0
  v_add_f32_dpp v64, v64, v64 row_bcast:15 row_mask:0xa bank_mask:0xf
  v_add_f32_dpp v65, v65, v65 row_bcast:15 row_mask:0xa bank_mask:0xf
  v_add_f32_dpp v66, v66, v66 row_bcast:15 row_mask:0xa bank_mask:0xf
  v_add_f32_dpp v67, v67, v67 row_bcast:15 row_mask:0xa bank_mask:0xf
  v_cndmask_b32 v68, v64, v65, s[6:7]
  v_cndmask_b32 v69, v66, v67, s[6:7]
  v_lshlrev_b32 v72, 16, v72
  v_lshlrev_b32 v73, 16, v73
  v_cndmask_b32 v68, v68, v69, s[40:41]
  v_add_f32 v72, v72, v73
  v_add_f32 v68, v68, v72
  v_cvt_pk_bf16_f32 v70, v68, v68
  s_mov_b64 exec, 0xf0000
  s_mov_b32 exec_hi, 0xf0000
  buffer_store_short v70, v43, s[48:51], 0 offen
  s_mov_b64 exec, 1
  s_cmp_lg_u32 s2, 0
  s_cbranch_scc1 L_noepoch
  v_mov_b32 v42, 0
  buffer_store_dword v20, v42, s[36:39], 0 offen sc1
L_noepoch:
  s_mov_b64 exec, -1
  s_branch L_fin_stamps
L_sync_t:
  s_load_dwordx2 s[40:41], s[0:1], 56
  s_mov_b32 s42, 9216
  s_mov_b32 s43, 0x20000
  s_mul_i32 s4, s54, 288
  v_lshlrev_b32 v5, 3, v0
  v_mov_b32 v6, 2146435072
  v_cmp_gt_u32 vcc, 36, v0
  s_waitcnt lgkmcnt(0)
  s_nop 0
  v_cndmask_b32 v5, v6, v5, vcc
  buffer_load_dwordx2 v[12:13], v5, s[40:43], s4 offen
  s_mov_b32 s96, 0x7060500
  s_mov_b32 s97, 0x7060501
  s_mov_b32 s98, 0x7060502
  s_mov_b32 s99, 0x7060503
  s_mov_b32 s100, 0x0c0c0400
  s_mov_b32 s101, 0x04000c0c
  v_lshlrev_b32 v16, 3, v0
  v_lshlrev_b32 v17, 4, v0
  v_cmp_le_u32 vcc, 18, v0
  v_mov_b32 v18, 0
  v_mov_b32 v19, 224
  v_cndmask_b32 v18, v18, v19, vcc
  v_add_u32 v18, v17, v18
  v_mov_b32 v14, 1
  s_lshl_b32 s4, s52, 13
  s_add_u32 s4, s4, 57344
  s_add_u32 s20, s4, 0
  s_add_u32 s21, s4, 2048
  s_add_u32 s22, s4, 4096
  s_add_u32 s23, s4, 6144
  s_add_u32 s24, s4, 1024
  s_add_u32 s25, s4, 3072
  s_add_u32 s26, s4, 5120
  s_add_u32 s27, s4, 7168
  s_lshl_b32 s4, s54, 12
  s_add_u32 s4, s4, 188416
  s_add_u32 s28, s4, 0
  s_add_u32 s29, s4, 1024
  s_add_u32 s30, s4, 2048
  s_add_u32 s31, s4, 3072
  s_getreg_b32 s35, hwreg(HW_REG_XCC_ID, 0, 4)
  s_mov_b32 s44, 0
  s_waitcnt vmcnt(1)
  v_add_u32 v15, 0x9e3779b9, v4
  ds_write_b32 v7, v15 offset:48
  s_mov_b32 s63, 2000000
L_sp61:
  ds_read_b32 v8, v7 offset:4
  s_sub_u32 s63, s63, 1
  s_cbranch_scc1 L_spx62
  s_waitcnt lgkmcnt(0)
  v_readfirstlane_b32 s62, v8
  s_cmp_ge_u32 s62, 4
  s_cbranch_scc0 L_sp61
L_spx62:
  ds_read_b64 v[20:21], v16 offset:2624
  ds_read_b64 v[22:23], v16 offset:2880
  ds_read_b64 v[24:25], v16 offset:3136
  ds_read_b64 v[26:27], v16 offset:3392
  ds_read_b64 v[28:29], v16 offset:3648
  ds_read_b64 v[30:31], v16 offset:3904
  ds_read_b64 v[32:33], v16 offset:4160
  ds_read_b64 v[34:35], v16 offset:4416
  s_lshl_b32 s4, s52, 4
  s_add_u32 s4, s4, s53
  s_lshl_b32 s4, s4, 9
  s_add_u32 s4, s4, 57344
  s_waitcnt lgkmcnt(0)
  v_add_f32 v20, v20, v22
  v_add_f32 v24, v24, v26
  v_add_f32 v28, v28, v30
  v_add_f32 v32, v32, v34
  v_add_f32 v20, v20, v24
  v_add_f32 v28, v28, v32
  v_add_f32 v20, v20, v28
  v_add_f32 v21, v21, v23
  v_add_f32 v25, v25, v27
  v_add_f32 v29, v29, v31
  v_add_f32 v33, v33, v35
  v_add_f32 v21, v21, v25
  v_add_f32 v29, v29, v33
  v_add_f32 v21, v21, v29
  v_mov_b32 v92, v20
  v_mov_b32 v93, v15
  v_mov_b32 v94, v21
  v_add_u32 v95, s35, v15
  s_mov_b32 s45, s4
  s_mov_b32 exec_hi, 0
  buffer_store_dwordx4 v[92:95], v17, s[36:39], s4 offen
  s_mov_b32 exec_hi, -1
  s_mov_b32 s63, 2000000
L_sp63:
  ds_read_b32 v8, v7 offset:8
  s_sub_u32 s63, s63, 1
  s_cbranch_scc1 L_spx64
  s_waitcnt lgkmcnt(0)
  v_readfirstlane_b32 s62, v8
  s_cmp_ge_u32 s62, 4
  s_cbranch_scc0 L_sp63
L_spx64:
  ds_read_b128 v[24:27], v17 offset:4672
  ds_read_b128 v[28:31], v17 offset:4960
  ds_read_b128 v[32:35], v17 offset:5248
  ds_read_b128 v[36:39], v17 offset:5536
  s_lshl_b32 s4, s54, 3
  s_add_u32 s4, s4, s55
  s_lshl_b32 s4, s4, 9
  s_add_u32 s4, s4, 188416
  s_waitcnt lgkmcnt(0)
  v_add_f32 v24, v24, v28
  v_add_f32 v32, v32, v36
  v_add_f32 v25, v25, v29
  v_add_f32 v33, v33, v37
  v_add_f32 v26, v26, v30
  v_add_f32 v34, v34, v38
  v_add_f32 v27, v27, v31
  v_add_f32 v35, v35, v39
  v_add_f32 v24, v24, v32
  v_add_f32 v25, v25, v33
  v_add_f32 v26, v26, v34
  v_add_f32 v27, v27, v35
  v_perm_b32 v24, v24, v15, s96
  v_perm_b32 v25, v25, v15, s97
  v_perm_b32 v26, v26, v15, s98
  v_perm_b32 v27, v27, v15, s99
  v_mov_b32 v96, v24
  v_mov_b32 v97, v25
  v_mov_b32 v98, v26
  v_mov_b32 v99, v27
  s_mov_b32 s46, s4
  s_mov_b64 exec, 0x3ffff
  buffer_store_dwordx4 v[96:99], v17, s[36:39], s4 offen
  s_mov_b64 exec, -1
  s_mov_b32 s5, 0
  buffer_load_dwordx4 v[40:43], v17, s[36:39], s20 offen sc1
  buffer_load_dwordx4 v[44:47], v17, s[36:39], s21 offen sc1
  buffer_load_dwordx4 v[48:51], v17, s[36:39], s22 offen sc1
  buffer_load_dwordx4 v[52:55], v17, s[36:39], s23 offen sc1
  buffer_load_dwordx4 v[56:59], v17, s[36:39], s24 offen sc1
  buffer_load_dwordx4 v[60:63], v17, s[36:39], s25 offen sc1
  buffer_load_dwordx4 v[64:67], v17, s[36:39], s26 offen sc1
  buffer_load_dwordx4 v[68:71], v17, s[36:39], s27 offen sc1
  s_mov_b32 exec_hi, 0xf
  buffer_load_dwordx4 v[104:107], v18, s[36:39], s28 offen sc1
  buffer_load_dwordx4 v[108:111], v18, s[36:39], s29 offen sc1
  buffer_load_dwordx4 v[112:115], v18, s[36:39], s30 offen sc1
  buffer_load_dwordx4 v[116:119], v18, s[36:39], s31 offen sc1
  s_mov_b32 exec_hi, -1
L_qcheck:
  s_waitcnt vmcnt(0)
  v_xor_b32 v20, v41, v15
  v_sub_u32 v21, v43, v15
  v_lshrrev_b32 v22, 4, v21
  v_or_b32 v19, v20, v22
  v_xor_b32 v100, s35, v21
  v_xor_b32 v20, v45, v15
  v_sub_u32 v21, v47, v15
  v_lshrrev_b32 v22, 4, v21
  v_or3_b32 v19, v19, v20, v22
  v_xor_b32 v21, s35, v21
  v_or_b32 v100, v100, v21
  v_xor_b32 v20, v49, v15
  v_sub_u32 v21, v51, v15
  v_lshrrev_b32 v22, 4, v21
  v_or3_b32 v19, v19, v20, v22
  v_xor_b32 v21, s35, v21
  v_or_b32 v100, v100, v21
  v_xor_b32 v20, v53, v15
  v_sub_u32 v21, v55, v15
  v_lshrrev_b32 v22, 4, v21
  v_or3_b32 v19, v19, v20, v22
  v_xor_b32 v21, s35, v21
  v_or_b32 v100, v100, v21
  v_xor_b32 v20, v57, v15
  v_sub_u32 v21, v59, v15
  v_lshrrev_b32 v22, 4, v21
  v_or3_b32 v19, v19, v20, v22
  v_xor_b32 v21, s35, v21
  v_or_b32 v100, v100, v21
  v_xor_b32 v20, v61, v15
  v_sub_u32 v21, v63, v15
  v_lshrrev_b32 v22, 4, v21
  v_or3_b32 v19, v19, v20, v22
  v_xor_b32 v21, s35, v21
  v_or_b32 v100, v100, v21
  v_xor_b32 v20, v65, v15
  v_sub_u32 v21, v67, v15
  v_lshrrev_b32 v22, 4, v21
  v_or3_b32 v19, v19, v20, v22
  v_xor_b32 v21, s35, v21
  v_or_b32 v100, v100, v21
  v_xor_b32 v20, v69, v15
  v_sub_u32 v21, v71, v15
  v_lshrrev_b32 v22, 4, v21
  v_or3_b32 v19, v19, v20, v22
  v_xor_b32 v21, s35, v21
  v_or_b32 v100, v100, v21
  v_cmp_ne_u32 vcc, 0, v19
  v_perm_b32 v20, v105, v104, s100
  v_perm_b32 v21, v107, v106, s101
  v_or_b32 v20, v20, v21
  v_cmp_ne_u32 s[10:11], v20, v15
  v_perm_b32 v20, v109, v108, s100
  v_perm_b32 v21, v111, v110, s101
  v_or_b32 v20, v20, v21
  v_cmp_ne_u32 s[14:15], v20, v15
  s_or_b64 s[10:11], s[10:11], s[14:15]
  v_perm_b32 v20, v113, v112, s100
  v_perm_b32 v21, v115, v114, s101
  v_or_b32 v20, v20, v21
  v_cmp_ne_u32 s[14:15], v20, v15
  s_or_b64 s[10:11], s[10:11], s[14:15]
  v_perm_b32 v20, v117, v116, s100
  v_perm_b32 v21, v119, v118, s101
  v_or_b32 v20, v20, v21
  v_cmp_ne_u32 s[14:15], v20, v15
  s_or_b64 s[10:11], s[10:11], s[14:15]
  s_and_b32 s11, s11, 0xf
  s_cbranch_vccz L_qdone
  s_add_u32 s5, s5, 1
  s_sub_i32 s32, s5, 6
  s_bitcmp1_b32 s32, 0
  s_cselect_b32 s32, -1, 1
  s_mul_i32 s32, s32, 589824
  s_cmp_lt_u32 s5, 6
  s_cselect_b32 s32, 0, s32
  s_add_u32 s20, s20, s32
  s_add_u32 s21, s21, s32
  s_add_u32 s22, s22, s32
  s_add_u32 s23, s23, s32
  s_add_u32 s24, s24, s32
  s_add_u32 s25, s25, s32
  s_add_u32 s26, s26, s32
  s_add_u32 s27, s27, s32
  s_add_u32 s28, s28, s32
  s_add_u32 s29, s29, s32
  s_add_u32 s30, s30, s32
  s_add_u32 s31, s31, s32
  s_cmp_lt_u32 s5, 6
  s_cbranch_scc1 L_qnob
  s_mov_b64 s[48:49], vcc
  s_cmp_lg_u32 s44, 0
  s_cbranch_scc1 L_qb1
  s_mov_b32 s44, 1
  s_add_u32 s47, s45, 589824
  s_mov_b64 exec, 0xffffffff
  buffer_store_dwordx4 v[92:95], v17, s[36:39], s47 offen sc1
  s_add_u32 s47, s46, 589824
  s_mov_b64 exec, 0x3ffff
  buffer_store_dwordx4 v[96:99], v17, s[36:39], s47 offen sc1
  s_mov_b64 exec, -1
L_qb1:
  s_mov_b64 vcc, s[48:49]
L_qnob:
  s_cmp_gt_u32 s5, 200000
  s_cbranch_scc1 L_qdone
  s_mov_b64 exec, vcc
  buffer_load_dwordx4 v[40:43], v17, s[36:39], s20 offen sc1
  buffer_load_dwordx4 v[44:47], v17, s[36:39], s21 offen sc1
  buffer_load_dwordx4 v[48:51], v17, s[36:39], s22 offen sc1
  buffer_load_dwordx4 v[52:55], v17, s[36:39], s23 offen sc1
  buffer_load_dwordx4 v[56:59], v17, s[36:39], s24 offen sc1
  buffer_load_dwordx4 v[60:63], v17, s[36:39], s25 offen sc1
  buffer_load_dwordx4 v[64:67], v17, s[36:39], s26 offen sc1
  buffer_load_dwordx4 v[68:71], v17, s[36:39], s27 offen sc1
  s_mov_b64 exec, s[10:11]
  s_cbranch_execz L_qnoh
  buffer_load_dwordx4 v[104:107], v18, s[36:39], s28 offen sc1
  buffer_load_dwordx4 v[108:111], v18, s[36:39], s29 offen sc1
  buffer_load_dwordx4 v[112:115], v18, s[36:39], s30 offen sc1
  buffer_load_dwordx4 v[116:119], v18, s[36:39], s31 offen sc1
L_qnoh:
  s_mov_b64 exec, -1
  s_branch L_qcheck
L_qdone:
  v_add_f32 v40, v40, v44
  v_add_f32 v48, v48, v52
  v_add_f32 v40, v40, v48
  v_add_f32 v42, v42, v46
  v_add_f32 v50, v50, v54
  v_add_f32 v42, v42, v50
  v_cvt_pk_bf16_f32 v20, v40, v42
  v_add_f32 v56, v56, v60
  v_add_f32 v64, v64, v68
  v_add_f32 v56, v56, v64
  v_add_f32 v58, v58, v62
  v_add_f32 v66, v66, v70
  v_add_f32 v58, v58, v66
  v_cvt_pk_bf16_f32 v21, v56, v58
  v_lshlrev_b32 v19, 2, v0
  ds_write_b32 v19, v20 offset:5824
  ds_write_b32 v19, v21 offset:6080
  ds_write_b32 v7, v14 offset:24
  v_cmp_ne_u32 vcc, 0, v100
  s_cbranch_vccz L_qb3
  s_cmp_lg_u32 s44, 0
  s_cbranch_scc1 L_qb2
  s_mov_b32 s44, 1
  s_add_u32 s47, s45, 589824
  s_mov_b64 exec, 0xffffffff
  buffer_store_dwordx4 v[92:95], v17, s[36:39], s47 offen sc1
  s_add_u32 s47, s46, 589824
  s_mov_b64 exec, 0x3ffff
  buffer_store_dwordx4 v[96:99], v17, s[36:39], s47 offen sc1
  s_mov_b64 exec, -1
L_qb2:
L_qb3:
L_hloop:
  s_cmp_eq_u64 s[10:11], 0
  s_cbranch_scc1 L_hdone
  s_add_u32 s5, s5, 1
  s_sub_i32 s32, s5, 6
  s_bitcmp1_b32 s32, 0
  s_cselect_b32 s32, -1, 1
  s_mul_i32 s32, s32, 589824
  s_cmp_lt_u32 s5, 6
  s_cselect_b32 s32, 0, s32
  s_add_u32 s28, s28, s32
  s_add_u32 s29, s29, s32
  s_add_u32 s30, s30, s32
  s_add_u32 s31, s31, s32
  s_cmp_lt_u32 s5, 6
  s_cbranch_scc1 L_hnob
  s_cmp_lg_u32 s44, 0
  s_cbranch_scc1 L_hb1
  s_mov_b32 s44, 1
  s_add_u32 s47, s45, 589824
  s_mov_b64 exec, 0xffffffff
  buffer_store_dwordx4 v[92:95], v17, s[36:39], s47 offen sc1
  s_add_u32 s47, s46, 589824
  s_mov_b64 exec, 0x3ffff
  buffer_store_dwordx4 v[96:99], v17, s[36:39], s47 offen sc1
  s_mov_b64 exec, -1
L_hb1:
L_hnob:
  s_cmp_gt_u32 s5, 200000
  s_cbranch_scc1 L_hdone
  s_mov_b64 exec, s[10:11]
  buffer_load_dwordx4 v[104:107], v18, s[36:39], s28 offen sc1
  buffer_load_dwordx4 v[108:111], v18, s[36:39], s29 offen sc1
  buffer_load_dwordx4 v[112:115], v18, s[36:39], s30 offen sc1
  buffer_load_dwordx4 v[116:119], v18, s[36:39], s31 offen sc1
  s_mov_b64 exec, -1
  s_waitcnt vmcnt(0)
  v_perm_b32 v20, v105, v104, s100
  v_perm_b32 v21, v107, v106, s101
  v_or_b32 v20, v20, v21
  v_cmp_ne_u32 s[10:11], v20, v15
  v_perm_b32 v20, v109, v108, s100
  v_perm_b32 v21, v111, v110, s101
  v_or_b32 v20, v20, v21
  v_cmp_ne_u32 s[14:15], v20, v15
  s_or_b64 s[10:11], s[10:11], s[14:15]
  v_perm_b32 v20, v113, v112, s100
  v_perm_b32 v21, v115, v114, s101
  v_or_b32 v20, v20, v21
  v_cmp_ne_u32 s[14:15], v20, v15
  s_or_b64 s[10:11], s[10:11], s[14:15]
  v_perm_b32 v20, v117, v116, s100
  v_perm_b32 v21, v119, v118, s101
  v_or_b32 v20, v20, v21
  v_cmp_ne_u32 s[14:15], v20, v15
  s_or_b64 s[10:11], s[10:11], s[14:15]
  s_and_b32 s11, s11, 0xf
  s_branch L_hloop
L_hdone:
  s_mov_b32 exec_hi, 0xf
  v_and_b32 v104, 0xffffff00, v104
  v_and_b32 v108, 0xffffff00, v108
  v_and_b32 v112, 0xffffff00, v112
  v_and_b32 v116, 0xffffff00, v116
  v_add_f32 v104, v104, v108
  v_add_f32 v112, v112, v116
  v_add_f32 v104, v104, v112
  v_and_b32 v105, 0xffffff00, v105
  v_and_b32 v109, 0xffffff00, v109
  v_and_b32 v113, 0xffffff00, v113
  v_and_b32 v117, 0xffffff00, v117
  v_add_f32 v105, v105, v109
  v_add_f32 v113, v113, v117
  v_add_f32 v105, v105, v113
  v_and_b32 v106, 0xffffff00, v106
  v_and_b32 v110, 0xffffff00, v110
  v_and_b32 v114, 0xffffff00, v114
  v_and_b32 v118, 0xffffff00, v118
  v_add_f32 v106, v106, v110
  v_add_f32 v114, v114, v118
  v_add_f32 v106, v106, v114
  v_and_b32 v107, 0xffffff00, v107
  v_and_b32 v111, 0xffffff00, v111
  v_and_b32 v115, 0xffffff00, v115
  v_and_b32 v119, 0xffffff00, v119
  v_add_f32 v107, v107, v111
  v_add_f32 v115, v115, v119
  v_add_f32 v107, v107, v115
  v_cvt_pk_bf16_f32 v20, v104, v105
  v_lshlrev_b32 v104, 16, v20
  v_and_b32 v105, 0xffff0000, v20
  v_lshlrev_b32 v21, 16, v12
  v_and_b32 v22, 0xffff0000, v12
  v_add_f32 v104, v104, v21
  v_add_f32 v105, v105, v22
  v_cvt_pk_bf16_f32 v20, v104, v105
  v_lshlrev_b32 v104, 16, v20
  v_and_b32 v105, 0xffff0000, v20
  v_max_f32 v104, 0, v104
  v_max_f32 v105, 0, v105
  v_mul_f32 v104, v104, v104
  v_mul_f32 v105, v105, v105
  v_cvt_pk_bf16_f32 v104, v104, v104
  v_cvt_pk_bf16_f32 v105, v105, v105
  v_cvt_pk_bf16_f32 v20, v106, v107
  v_lshlrev_b32 v106, 16, v20
  v_and_b32 v107, 0xffff0000, v20
  v_lshlrev_b32 v21, 16, v13
  v_and_b32 v22, 0xffff0000, v13
  v_add_f32 v106, v106, v21
  v_add_f32 v107, v107, v22
  v_cvt_pk_bf16_f32 v20, v106, v107
  v_lshlrev_b32 v106, 16, v20
  v_and_b32 v107, 0xffff0000, v20
  v_max_f32 v106, 0, v106
  v_max_f32 v107, 0, v107
  v_mul_f32 v106, v106, v106
  v_mul_f32 v107, v107, v107
  v_cvt_pk_bf16_f32 v106, v106, v106
  v_cvt_pk_bf16_f32 v107, v107, v107
  ds_write_b128 v17, v[104:107] offset:6336
  s_mov_b64 exec, -1
  ds_write_b32 v7, v14 offset:28
  v_mul_u32_u24 v22, 57, v0
  v_lshrrev_b32 v22, 9, v22
  v_lshlrev_b32 v22, 2, v22
  ds_read_b32 v40, v22 offset:6336
  ds_read_b32 v41, v22 offset:6364
  ds_read_b32 v42, v22 offset:6392
  ds_read_b32 v43, v22 offset:6420
  ds_read_b32 v44, v22 offset:6448
  ds_read_b32 v45, v22 offset:6476
  ds_read_b32 v46, v22 offset:6504
  ds_read_b32 v47, v22 offset:6532
  ds_read_b32 v48, v22 offset:6560
  ds_read_b32 v49, v22 offset:6588
  ds_read_b32 v50, v22 offset:6616
  ds_read_b32 v51, v22 offset:6644
  ds_read_b32 v52, v22 offset:6672
  ds_read_b32 v53, v22 offset:6700
  ds_read_b32 v54, v22 offset:6728
  ds_read_b32 v55, v22 offset:6756
  ds_read_b32 v56, v22 offset:6784
  ds_read_b32 v57, v22 offset:6812
  ds_read_b32 v58, v22 offset:6840
  ds_read_b32 v59, v22 offset:6868
  ds_read_b32 v60, v22 offset:6896
  v_mov_b32 v23, 0
  v_lshlrev_b32 v19, 2, v0
  s_waitcnt lgkmcnt(0)
  v_cmp_ne_u32 vcc, 0, v60
  s_nop 1
  v_addc_co_u32 v23, vcc, v23, v23, vcc
  v_cmp_ne_u32 vcc, 0, v59
  s_nop 1
  v_addc_co_u32 v23, vcc, v23, v23, vcc
  v_cmp_ne_u32 vcc, 0, v58
  s_nop 1
  v_addc_co_u32 v23, vcc, v23, v23, vcc
  v_cmp_ne_u32 vcc, 0, v57
  s_nop 1
  v_addc_co_u32 v23, vcc, v23, v23, vcc
  v_cmp_ne_u32 vcc, 0, v56
  s_nop 1
  v_addc_co_u32 v23, vcc, v23, v23, vcc
  v_cmp_ne_u32 vcc, 0, v55
  s_nop 1
  v_addc_co_u32 v23, vcc, v23, v23, vcc
  v_cmp_ne_u32 vcc, 0, v54
  s_nop 1
  v_addc_co_u32 v23, vcc, v23, v23, vcc
  v_cmp_ne_u32 vcc, 0, v53
  s_nop 1
  v_addc_co_u32 v23, vcc, v23, v23, vcc
  v_cmp_ne_u32 vcc, 0, v52
  s_nop 1
  v_addc_co_u32 v23, vcc, v23, v23, vcc
  v_cmp_ne_u32 vcc, 0, v51
  s_nop 1
  v_addc_co_u32 v23, vcc, v23, v23, vcc
  v_cmp_ne_u32 vcc, 0, v50
  s_nop 1
  v_addc_co_u32 v23, vcc, v23, v23, vcc
  v_cmp_ne_u32 vcc, 0, v49
  s_nop 1
  v_addc_co_u32 v23, vcc, v23, v23, vcc
  v_cmp_ne_u32 vcc, 0, v48
  s_nop 1
  v_addc_co_u32 v23, vcc, v23, v23, vcc
  v_cmp_ne_u32 vcc, 0, v47
  s_nop 1
  v_addc_co_u32 v23, vcc, v23, v23, vcc
  v_cmp_ne_u32 vcc, 0, v46
  s_nop 1
  v_addc_co_u32 v23, vcc, v23, v23, vcc
  v_cmp_ne_u32 vcc, 0, v45
  s_nop 1
  v_addc_co_u32 v23, vcc, v23, v23, vcc
  v_cmp_ne_u32 vcc, 0, v44
  s_nop 1
  v_addc_co_u32 v23, vcc, v23, v23, vcc
  v_cmp_ne_u32 vcc, 0, v43
  s_nop 1
  v_addc_co_u32 v23, vcc, v23, v23, vcc
  v_cmp_ne_u32 vcc, 0, v42
  s_nop 1
  v_addc_co_u32 v23, vcc, v23, v23, vcc
  v_cmp_ne_u32 vcc, 0, v41
  s_nop 1
  v_addc_co_u32 v23, vcc, v23, v23, vcc
  v_cmp_ne_u32 vcc, 0, v40
  s_nop 1
  v_addc_co_u32 v23, vcc, v23, v23, vcc
  ds_write_b32 v19, v23 offset:11680
  ds_write_b32 v7, v14 offset:40
  v_and_b32 v22, 1, v0
  v_lshlrev_b32 v22, 13, v22
  v_bfe_u32 v23, v0, 1, 1
  v_lshl_add_u32 v22, v23, 10, v22
  v_bfe_u32 v23, v0, 2, 2
  v_lshl_add_u32 v22, v23, 8, v22
  v_lshl_add_u32 v90, v1, 11, v22
  s_lshl_b32 s34, s52, 14
  s_lshl_b32 s6, s53, 4
  s_add_u32 s34, s34, s6
  s_add_u32 s34, s34, 909312
  v_and_b32 v22, 1, v0
  v_lshlrev_b32 v91, 8, v22
  s_lshl_b32 s7, s52, 9
  s_add_u32 s7, s7, s6
  s_add_u32 s7, s7, 1171456
  s_cmp_eq_u32 s44, 0
  s_cbranch_scc1 L_noob
  s_mov_b32 s63, 2000000
L_sp65:
  ds_read_b32 v8, v7 offset:16
  s_sub_u32 s63, s63, 1
  s_cbranch_scc1 L_spx66
  s_waitcnt lgkmcnt(0)
  v_readfirstlane_b32 s62, v8
  s_cmp_ge_u32 s62, 4
  s_cbranch_scc0 L_sp65
L_spx66:
  ds_read_b128 v[40:43], v17 offset:8064
  ds_read_b128 v[44:47], v17 offset:9088
  s_waitcnt lgkmcnt(0)
  buffer_store_dwordx4 v[40:43], v90, s[36:39], s34 offen sc1
  s_mov_b64 exec, 3
  buffer_store_dwordx4 v[44:47], v91, s[36:39], s7 offen sc1
  s_mov_b64 exec, -1
L_noob:
  s_lshl_b32 s6, s55, 5
  s_add_u32 s6, s6, s54
  s_mul_i32 s6, s6, 384
  s_add_u32 s6, s6, 1245184
  s_setprio 0
  s_mov_b32 s63, 2000000
L_sp67:
  ds_read_b32 v8, v7 offset:20
  s_sub_u32 s63, s63, 1
  s_cbranch_scc1 L_spx68
  s_waitcnt lgkmcnt(0)
  v_readfirstlane_b32 s62, v8
  s_cmp_ge_u32 s62, 4
  s_cbranch_scc0 L_sp67
L_spx68:
  ds_read_b128 v[40:43], v17 offset:9120
  ds_read_b128 v[44:47], v17 offset:9696
  ds_read_b128 v[48:51], v17 offset:10272
  ds_read_b128 v[52:55], v17 offset:10848
  ds_read_b128 v[56:59], v17 offset:9408
  ds_read_b128 v[60:63], v17 offset:9984
  ds_read_b128 v[64:67], v17 offset:10560
  ds_read_b128 v[68:71], v17 offset:11136
  s_waitcnt lgkmcnt(0)
  v_add_f32 v40, v40, v56
  v_add_f32 v41, v41, v57
  v_add_f32 v42, v42, v58
  v_add_f32 v43, v43, v59
  v_add_f32 v44, v44, v60
  v_add_f32 v45, v45, v61
  v_add_f32 v46, v46, v62
  v_add_f32 v47, v47, v63
  v_add_f32 v48, v48, v64
  v_add_f32 v49, v49, v65
  v_add_f32 v50, v50, v66
  v_add_f32 v51, v51, v67
  v_add_f32 v52, v52, v68
  v_add_f32 v53, v53, v69
  v_add_f32 v54, v54, v70
  v_add_f32 v55, v55, v71
  v_add_f32 v40, v40, v44
  v_add_f32 v48, v48, v52
  v_add_f32 v41, v41, v45
  v_add_f32 v49, v49, v53
  v_add_f32 v42, v42, v46
  v_add_f32 v50, v50, v54
  v_add_f32 v43, v43, v47
  v_add_f32 v51, v51, v55
  v_add_f32 v40, v40, v48
  v_add_f32 v41, v41, v49
  v_add_f32 v42, v42, v50
  v_add_f32 v43, v43, v51
  v_perm_b32 v40, v40, v15, s96
  v_perm_b32 v41, v41, v15, s97
  v_perm_b32 v42, v42, v15, s98
  v_perm_b32 v43, v43, v15, s99
  s_mov_b64 exec, 0x3ffff
  buffer_store_dwordx4 v[40:43], v17, s[36:39], s6 offen sc1
  s_mov_b64 exec, -1
L_fin_stamps:
L_end:
  s_endpgm
.section .rodata,"a"
.p2align 6
.amdhsa_kernel parallel_sum__sliding_block_cached__dense_activation_squared_relu__decode_kernel
  .amdhsa_next_free_vgpr 256
  .amdhsa_next_free_sgpr 102
  .amdhsa_accum_offset 256
  .amdhsa_group_segment_fixed_size 0
  .amdhsa_kernarg_size 104
  .amdhsa_user_sgpr_count 2
  .amdhsa_user_sgpr_kernarg_segment_ptr 1
  .amdhsa_system_sgpr_workgroup_id_x 1
.end_amdhsa_kernel
```
